```python
import torch

def _softmax(x, axis=-1):
    return torch.softmax(x, dim=axis)
def _gelu(x):
    return torch.nn.functional.gelu(x, approximate="tanh")
def _silu(x):
    return torch.nn.functional.silu(x)
def _sigmoid(x):
    return torch.sigmoid(x)
def _layernorm(x, axis=-1, eps=1e-5):
    m = x.mean(dim=axis, keepdim=True)
    v = x.var(dim=axis, keepdim=True, unbiased=False)
    return (x - m) / torch.sqrt(v + eps)
def _scatter_add(tgt, idx, src, axis=0):
    return tgt.clone().index_add_(axis, idx, src)
def _segment_sum(src, seg, n):
    out = torch.zeros((n,) + src.shape[1:], dtype=src.dtype)
    return out.index_add_(0, seg, src)
def _pad(x, pw):
    flat = tuple(v for pair in reversed(pw) for v in pair)
    return torch.nn.functional.pad(x, flat)

kernel_name = 'parallel_sum__gqa_block_cached__glu_gated_geglu__decode'

def setup_inputs():

    _w = (lambda a: (lambda t: t.to(torch.bfloat16) if t.is_floating_point() else t)(torch.as_tensor(a)))
    def _A_setup():
        B, Sq, D = 4, 1, 448
        Hq, Hkv, Sk, Dh = 16, 8, 8192, 256
        assert Hq % Hkv == 0, (Hq, Hkv)
        return {
            "x": _w((lambda *s: torch.randn(*s, dtype=torch.bfloat16) * 0.05)(B, Sq, D)),
            "k_cache": _w((lambda *s: torch.randn(*s, dtype=torch.bfloat16) * 1.6)(B, Hkv, Sk, Dh)),
            "v_cache": _w((lambda *s: torch.randn(*s, dtype=torch.bfloat16) * 0.8)(B, Hkv, Sk, Dh)),
            "wq": _w((lambda *s: torch.randn(*s, dtype=torch.bfloat16) * 1.6)(D, Hq * Dh) * (D ** -0.5)),
            "wo": _w((lambda *s: torch.randn(*s, dtype=torch.bfloat16) * 0.8)(Hq * Dh, D) * ((Hq * Dh) ** -0.5)),
        }
    _A_in = _A_setup()

    def _B_setup():
        B, S, Dm, Df = 4, 1, 448, 1792
        return {
            "x": _w((lambda *s: torch.randn(*s, dtype=torch.bfloat16) * 0.05)(B, S, Dm)),
            "w_gate": _w((lambda *s: torch.randn(*s, dtype=torch.bfloat16) * 0.4)(Dm, Df) * (Dm ** -0.5)),
            "w_up": _w((lambda *s: torch.randn(*s, dtype=torch.bfloat16) * 0.4)(Dm, Df) * (Dm ** -0.5)),
            "w_down": _w((lambda *s: torch.randn(*s, dtype=torch.bfloat16) * 0.4)(Df, Dm) * (Df ** -0.5)),
        }
    _B_in = _B_setup()

    return {
        "A_x": _A_in["x"],
        "A_k_cache": _A_in["k_cache"],
        "A_v_cache": _A_in["v_cache"],
        "A_wq": _A_in["wq"],
        "A_wo": _A_in["wo"],
        "B_x": _B_in["x"],
        "B_w_gate": _B_in["w_gate"],
        "B_w_up": _B_in["w_up"],
        "B_w_down": _B_in["w_down"],
    }

def reference(A_x, A_k_cache, A_v_cache, A_wq, A_wo, B_x, B_w_gate, B_w_up, B_w_down):
    def _A_ref(x, k_cache, v_cache, wq, wo):
        B, Sq, D = x.shape
        Hq, Dh = 16, 256
        Hkv = k_cache.shape[1]
        rep = Hq // Hkv
        q = (lambda x, *d: x.permute(*d))((x @ wq).reshape(B, Sq, Hq, Dh), 0, 2, 1, 3)
        k = (lambda x, n, axis: torch.repeat_interleave(x, n, dim=axis))(k_cache, rep, axis=1)
        v = (lambda x, n, axis: torch.repeat_interleave(x, n, dim=axis))(v_cache, rep, axis=1)
        scores = torch.einsum("bhqd,bhkd->bhqk", q, k) * (Dh ** -0.5)
        p = _softmax(scores, axis=-1)
        o = torch.einsum("bhqk,bhkd->bhqd", p, v)
        return (lambda x, *d: x.permute(*d))(o, 0, 2, 1, 3).reshape(B, Sq, Hq * Dh) @ wo

    def _B_ref(x, w_gate, w_up, w_down):
        g = torch.einsum("bsd,df->bsf", x, w_gate)
        u = torch.einsum("bsd,df->bsf", x, w_up)
        h = _gelu(g) * u
        return torch.einsum("bsf,fd->bsd", h, w_down)

    x = A_x
    xn = _layernorm(x, axis=-1)
    return x + _A_ref(xn, A_k_cache, A_v_cache, A_wq, A_wo) + _B_ref(xn, B_w_gate, B_w_up, B_w_down)
```

```asm
; @launch grid=(256,1,1) block=(512,1,1) lds=163264
.amdgcn_target "amdgcn-amd-amdhsa--gfx950"
.text
.globl parallel_sum__gqa_block_cached__glu_gated_geglu__decode_kernel
.p2align 8
.type parallel_sum__gqa_block_cached__glu_gated_geglu__decode_kernel,@function
parallel_sum__gqa_block_cached__glu_gated_geglu__decode_kernel:
  s_cmp_ge_u32 s2, 256
  s_cbranch_scc1 parallel_sum__gqa_block_cached__glu_gated_geglu__decode_kernel_done
  s_load_dwordx16 s[40:55], s[0:1], 0
  s_load_dwordx8 s[56:63], s[0:1], 64
  v_and_b32 v1, 63, v0
  v_lshrrev_b32 v2, 6, v0
  s_nop 0
  v_readfirstlane_b32 s3, v2
  s_nop 3
  s_cmp_ge_u32 s3, 4
  s_cbranch_scc1 parallel_sum__gqa_block_cached__glu_gated_geglu__decode_kernel_aux
  v_and_b32 v22, 15, v1
  v_lshrrev_b32 v23, 5, v1
  v_lshlrev_b32 v24, 1, v23
  v_xor_b32 v22, v22, v24
  v_lshlrev_b32 v22, 4, v22
  v_lshlrev_b32 v23, 9, v23
  v_and_b32 v24, 16, v1
  v_lshl_add_u32 v23, v24, 4, v23
  v_add_u32 v22, v22, v23
  v_add_u32 v23, 32768, v22
  v_mov_b32 v2, v22
  v_xor_b32 v3, 64, v22
  v_xor_b32 v4, 128, v22
  v_xor_b32 v5, 192, v22
  v_xor_b32 v6, 16, v23
  v_xor_b32 v7, 80, v23
  v_xor_b32 v8, 144, v23
  v_xor_b32 v9, 208, v23
  s_lshl_b32 s66, s3, 15
  s_lshr_b32 s4, s2, 3
  s_lshl_b32 s98, s4, 22
  s_and_b32 s5, s2, 7
  s_lshl_b32 s5, s5, 2
  s_add_u32 s99, s5, s3
  s_lshl_b32 s5, s99, 12
  s_add_u32 s68, s98, s5
  s_and_b32 s5, s2, 7
  s_lshr_b32 s96, s5, 1
  s_lshl_b32 s96, s96, 20
  s_and_b32 s5, s5, 1
  s_lshl_b32 s5, s5, 2
  s_add_u32 s5, s5, s3
  s_lshl_b32 s5, s5, 12
  s_add_u32 s96, s96, s5
  s_add_u32 s68, s98, s96
  s_mov_b32 s67, 0x3db8aa3b
  s_mov_b32 s69, s66
  s_mov_b32 s70, 2
  s_waitcnt lgkmcnt(0)
  s_mov_b32 s8, s42
  s_and_b32 s9, s43, 0xffff
  s_mov_b32 s10, 134217728
  s_mov_b32 s11, 0x20000
  s_add_u32 m0, s66, 0
  s_nop 0
  buffer_load_dwordx4 v2, s[8:11], s68 offen offset:0 nt lds
  buffer_load_dwordx4 v3, s[8:11], s68 offen offset:1024 nt lds
  buffer_load_dwordx4 v4, s[8:11], s68 offen offset:2048 nt lds
  buffer_load_dwordx4 v5, s[8:11], s68 offen offset:3072 nt lds
  s_add_u32 m0, s66, 4096
  s_nop 0
  buffer_load_dwordx4 v6, s[8:11], s68 offen offset:0 nt lds
  buffer_load_dwordx4 v7, s[8:11], s68 offen offset:1024 nt lds
  s_mov_b32 s12, s44
  s_and_b32 s13, s45, 0xffff
  s_mov_b32 s14, 134217728
  s_mov_b32 s15, 0x20000
  s_mov_b32 s16, s62
  s_and_b32 s17, s63, 0xffff
  s_mov_b32 s18, 2695168
  s_mov_b32 s19, 0x20000
  v_and_b32 v22, 15, v1
  v_lshlrev_b32 v23, 1, v22
  v_and_b32 v23, 15, v23
  v_lshrrev_b32 v24, 3, v22
  v_or_b32 v23, v23, v24
  v_lshrrev_b32 v24, 4, v1
  v_lshlrev_b32 v24, 1, v24
  v_xor_b32 v23, v23, v24
  v_lshlrev_b32 v23, 4, v23
  v_lshlrev_b32 v22, 9, v22
  v_add3_u32 v22, s66, v22, v23
  v_mov_b32 v10, v22
  v_xor_b32 v11, 16, v22
  v_xor_b32 v12, 128, v22
  v_xor_b32 v13, 144, v22
  v_lshrrev_b32 v22, 2, v1
  v_lshlrev_b32 v23, 1, v22
  v_and_b32 v23, 15, v23
  v_lshrrev_b32 v24, 3, v22
  v_or_b32 v23, v23, v24
  v_bfe_u32 v24, v1, 1, 1
  v_xor_b32 v23, v23, v24
  v_lshlrev_b32 v23, 4, v23
  v_lshlrev_b32 v22, 9, v22
  v_and_b32 v24, 1, v1
  v_lshl_add_u32 v22, v24, 3, v22
  v_add3_u32 v22, s66, v22, v23
  v_add_u32 v22, 8192, v22
  v_mov_b32 v14, v22
  v_xor_b32 v15, 32, v22
  v_xor_b32 v16, 64, v22
  v_xor_b32 v17, 96, v22
  v_xor_b32 v18, 128, v22
  v_xor_b32 v19, 160, v22
  v_xor_b32 v20, 192, v22
  v_xor_b32 v21, 224, v22
  v_mov_b32 v32, 0xf149f2ca
  v_mov_b32 v33, 0
  v_mov_b32 v38, 0
  v_mov_b32 v237, 0
  v_mov_b32 v22, 0xf149f2ca
  v_cmp_lt_u32 vcc, 31, v1
  s_nop 1
  v_cndmask_b32 v237, v237, v22, vcc
  v_and_b32 v27, 15, v1
  v_lshlrev_b32 v27, 9, v27
  v_lshrrev_b32 v28, 4, v1
  v_lshl_add_u32 v27, v28, 5, v27
  v_add_u32 v27, 159744, v27
  v_mov_b32 v29, 163200
  s_lshr_b32 s4, s2, 3
  s_lshl_b32 s4, s4, 8
  s_add_u32 s4, s4, 4096
  v_mov_b32 v236, s4
  v_mov_b32 v140, 0
  v_mov_b32 v141, 0
  v_mov_b32 v142, 0
  v_mov_b32 v143, 0
  v_mov_b32 v144, 0
  v_mov_b32 v145, 0
  v_mov_b32 v146, 0
  v_mov_b32 v147, 0
  v_mov_b32 v148, 0
  v_mov_b32 v149, 0
  v_mov_b32 v150, 0
  v_mov_b32 v151, 0
  v_mov_b32 v152, 0
  v_mov_b32 v153, 0
  v_mov_b32 v154, 0
  v_mov_b32 v155, 0
  v_mov_b32 v156, 0
  v_mov_b32 v157, 0
  v_mov_b32 v158, 0
  v_mov_b32 v159, 0
  v_mov_b32 v160, 0
  v_mov_b32 v161, 0
  v_mov_b32 v162, 0
  v_mov_b32 v163, 0
  v_mov_b32 v164, 0
  v_mov_b32 v165, 0
  v_mov_b32 v166, 0
  v_mov_b32 v167, 0
  v_mov_b32 v168, 0
  v_mov_b32 v169, 0
  v_mov_b32 v170, 0
  v_mov_b32 v171, 0
  v_mov_b32 v172, 0
  v_mov_b32 v173, 0
  v_mov_b32 v174, 0
  v_mov_b32 v175, 0
  v_mov_b32 v176, 0
  v_mov_b32 v177, 0
  v_mov_b32 v178, 0
  v_mov_b32 v179, 0
  v_mov_b32 v180, 0
  v_mov_b32 v181, 0
  v_mov_b32 v182, 0
  v_mov_b32 v183, 0
  v_mov_b32 v184, 0
  v_mov_b32 v185, 0
  v_mov_b32 v186, 0
  v_mov_b32 v187, 0
  v_mov_b32 v188, 0
  v_mov_b32 v189, 0
  v_mov_b32 v190, 0
  v_mov_b32 v191, 0
  v_mov_b32 v192, 0
  v_mov_b32 v193, 0
  v_mov_b32 v194, 0
  v_mov_b32 v195, 0
  v_mov_b32 v196, 0
  v_mov_b32 v197, 0
  v_mov_b32 v198, 0
  v_mov_b32 v199, 0
  v_mov_b32 v200, 0
  v_mov_b32 v201, 0
  v_mov_b32 v202, 0
  v_mov_b32 v203, 0
  v_mov_b32 v44, 0
  v_mov_b32 v45, 0
  v_mov_b32 v46, 0
  v_mov_b32 v47, 0
  v_mov_b32 v48, 0
  v_mov_b32 v49, 0
  v_mov_b32 v50, 0
  v_mov_b32 v51, 0
  v_mov_b32 v52, 0
  v_mov_b32 v53, 0
  v_mov_b32 v54, 0
  v_mov_b32 v55, 0
  v_mov_b32 v56, 0
  v_mov_b32 v57, 0
  v_mov_b32 v58, 0
  v_mov_b32 v59, 0
  v_mov_b32 v60, 0
  v_mov_b32 v61, 0
  v_mov_b32 v62, 0
  v_mov_b32 v63, 0
  v_mov_b32 v64, 0
  v_mov_b32 v65, 0
  v_mov_b32 v66, 0
  v_mov_b32 v67, 0
  v_mov_b32 v68, 0
  v_mov_b32 v69, 0
  v_mov_b32 v70, 0
  v_mov_b32 v71, 0
  v_mov_b32 v72, 0
  v_mov_b32 v73, 0
  v_mov_b32 v74, 0
  v_mov_b32 v75, 0
  s_barrier
  s_waitcnt vmcnt(5)
  buffer_load_dwordx4 v8, s[8:11], s68 offen offset:2048 nt lds
  s_waitcnt vmcnt(5)
  buffer_load_dwordx4 v9, s[8:11], s68 offen offset:3072 nt lds
  s_waitcnt vmcnt(5)
  s_add_u32 m0, s66, 8192
  s_nop 0
  buffer_load_dwordx4 v2, s[12:15], s68 offen offset:0 nt lds
  s_waitcnt vmcnt(5)
  buffer_load_dwordx4 v3, s[12:15], s68 offen offset:1024 nt lds
  s_waitcnt vmcnt(5)
  buffer_load_dwordx4 v4, s[12:15], s68 offen offset:2048 nt lds
  s_waitcnt vmcnt(5)
  buffer_load_dwordx4 v5, s[12:15], s68 offen offset:3072 nt lds
  s_waitcnt vmcnt(5)
  s_add_u32 m0, s66, 12288
  s_nop 0
  buffer_load_dwordx4 v6, s[12:15], s68 offen offset:0 nt lds
  s_waitcnt vmcnt(5)
  buffer_load_dwordx4 v7, s[12:15], s68 offen offset:1024 nt lds
  s_waitcnt vmcnt(5)
  buffer_load_dwordx4 v8, s[12:15], s68 offen offset:2048 nt lds
  s_waitcnt vmcnt(5)
  buffer_load_dwordx4 v9, s[12:15], s68 offen offset:3072 nt lds
  s_add_u32 s68, s68, 65536
  s_waitcnt vmcnt(5)
  s_add_u32 m0, s66, 16384
  s_nop 0
  buffer_load_dwordx4 v2, s[8:11], s68 offen offset:0 nt lds
  s_waitcnt vmcnt(5)
  buffer_load_dwordx4 v3, s[8:11], s68 offen offset:1024 nt lds
  s_waitcnt vmcnt(5)
  buffer_load_dwordx4 v4, s[8:11], s68 offen offset:2048 nt lds
  s_waitcnt vmcnt(5)
  buffer_load_dwordx4 v5, s[8:11], s68 offen offset:3072 nt lds
  s_waitcnt vmcnt(5)
  s_add_u32 m0, s66, 20480
  s_nop 0
  buffer_load_dwordx4 v6, s[8:11], s68 offen offset:0 nt lds
  s_waitcnt vmcnt(5)
  buffer_load_dwordx4 v7, s[8:11], s68 offen offset:1024 nt lds
  s_waitcnt vmcnt(5)
  buffer_load_dwordx4 v8, s[8:11], s68 offen offset:2048 nt lds
  s_waitcnt vmcnt(5)
  buffer_load_dwordx4 v9, s[8:11], s68 offen offset:3072 nt lds
  s_waitcnt vmcnt(5)
  s_add_u32 m0, s66, 24576
  s_nop 0
  buffer_load_dwordx4 v2, s[12:15], s68 offen offset:0 nt lds
  s_waitcnt vmcnt(5)
  buffer_load_dwordx4 v3, s[12:15], s68 offen offset:1024 nt lds
  s_waitcnt vmcnt(5)
  buffer_load_dwordx4 v4, s[12:15], s68 offen offset:2048 nt lds
  s_waitcnt vmcnt(5)
  buffer_load_dwordx4 v5, s[12:15], s68 offen offset:3072 nt lds
  s_waitcnt vmcnt(5)
  s_add_u32 m0, s66, 28672
  s_nop 0
  buffer_load_dwordx4 v6, s[12:15], s68 offen offset:0 nt lds
  s_waitcnt vmcnt(5)
  buffer_load_dwordx4 v7, s[12:15], s68 offen offset:1024 nt lds
  s_waitcnt vmcnt(5)
  buffer_load_dwordx4 v8, s[12:15], s68 offen offset:2048 nt lds
  s_waitcnt vmcnt(5)
  buffer_load_dwordx4 v9, s[12:15], s68 offen offset:3072 nt lds
  s_add_u32 s68, s68, 65536
  s_mov_b32 s71, 0x400000
L_ldswait_1:
  ds_read_b32 v30, v29 offset:4
  s_waitcnt lgkmcnt(0)
  v_readfirstlane_b32 s32, v30
  s_cmp_ge_u32 s32, 4
  s_cbranch_scc1 L_ldsdone_2
  s_sleep 1
  s_sub_u32 s71, s71, 1
  s_cmp_lg_u32 s71, 0
  s_cbranch_scc1 L_ldswait_1
L_ldsdone_2:
  s_mov_b32 exec_lo, 0x30003
  s_mov_b32 exec_hi, 0x30003
  ds_read_b128 v[44:47], v27 offset:0
  ds_read_b128 v[48:51], v27 offset:16
  ds_read_b128 v[52:55], v27 offset:128
  ds_read_b128 v[56:59], v27 offset:144
  ds_read_b128 v[60:63], v27 offset:256
  ds_read_b128 v[64:67], v27 offset:272
  ds_read_b128 v[68:71], v27 offset:384
  ds_read_b128 v[72:75], v27 offset:400
  s_mov_b64 exec, -1
  s_waitcnt lgkmcnt(0)
parallel_sum__gqa_block_cached__glu_gated_geglu__decode_kernel_loop:
  s_cmp_eq_u32 s70, 15
  s_cbranch_scc0 L_nomask_3
  v_mov_b32 v38, v237
L_nomask_3:
  s_waitcnt vmcnt(12)
  ds_read_b128 v[76:79], v10 offset:0
  ds_read_b128 v[80:83], v11 offset:0
  ds_read_b128 v[84:87], v12 offset:0
  ds_read_b128 v[88:91], v13 offset:0
  ds_read_b128 v[92:95], v10 offset:256
  ds_read_b128 v[96:99], v11 offset:256
  ds_read_b128 v[100:103], v12 offset:256
  ds_read_b128 v[104:107], v13 offset:256
  s_cmp_lt_u32 s70, 12
  s_cbranch_scc1 L_noatom_4
  v_mov_b32 v39, 1
  s_mov_b64 exec, 1
  buffer_atomic_add v39, v236, s[16:19], 0 offen sc0 sc1
  s_mov_b64 exec, -1
L_noatom_4:
  s_waitcnt lgkmcnt(7)
  v_mfma_f32_16x16x32_bf16 v[40:43], v[76:79], v[44:47], 0
  s_waitcnt lgkmcnt(6)
  v_mfma_f32_16x16x32_bf16 v[40:43], v[80:83], v[48:51], v[40:43]
  s_waitcnt lgkmcnt(5)
  v_mfma_f32_16x16x32_bf16 v[40:43], v[84:87], v[52:55], v[40:43]
  s_waitcnt lgkmcnt(4)
  v_mfma_f32_16x16x32_bf16 v[40:43], v[88:91], v[56:59], v[40:43]
  s_waitcnt lgkmcnt(3)
  v_mfma_f32_16x16x32_bf16 v[40:43], v[92:95], v[60:63], v[40:43]
  s_waitcnt lgkmcnt(2)
  v_mfma_f32_16x16x32_bf16 v[40:43], v[96:99], v[64:67], v[40:43]
  s_waitcnt lgkmcnt(1)
  v_mfma_f32_16x16x32_bf16 v[40:43], v[100:103], v[68:71], v[40:43]
  s_waitcnt lgkmcnt(0)
  v_mfma_f32_16x16x32_bf16 v[40:43], v[104:107], v[72:75], v[40:43]
  s_waitcnt vmcnt(6)
  s_add_u32 m0, s69, 0
  s_nop 0
  buffer_load_dwordx4 v2, s[8:11], s68 offen offset:0 nt lds
  s_waitcnt vmcnt(6)
  buffer_load_dwordx4 v3, s[8:11], s68 offen offset:1024 nt lds
  v_xor_b32 v10, 0x4000, v10
  v_xor_b32 v11, 0x4000, v11
  v_xor_b32 v12, 0x4000, v12
  v_xor_b32 v13, 0x4000, v13
  s_nop 3
  v_cvt_pk_bf16_f32 v22, v40, v41
  v_cvt_pk_bf16_f32 v23, v42, v43
  v_lshlrev_b32 v40, 16, v22
  v_and_b32 v41, 0xffff0000, v22
  v_lshlrev_b32 v42, 16, v23
  v_and_b32 v43, 0xffff0000, v23
  v_fma_f32 v40, v40, s67, v38
  v_fma_f32 v41, v41, s67, v38
  v_fma_f32 v42, v42, s67, v38
  v_fma_f32 v43, v43, s67, v38
  v_max3_f32 v35, v40, v41, v42
  v_max3_f32 v35, v35, v43, v32
  s_waitcnt vmcnt(6)
  buffer_load_dwordx4 v4, s[8:11], s68 offen offset:2048 nt lds
  v_mov_b32 v22, v35
  s_nop 1
  v_permlane16_swap_b32 v22, v35
  s_nop 0
  v_max_f32 v35, v35, v22
  v_mov_b32 v22, v35
  s_nop 1
  v_permlane32_swap_b32 v22, v35
  s_nop 0
  v_max_f32 v35, v35, v22
  s_waitcnt vmcnt(6)
  buffer_load_dwordx4 v5, s[8:11], s68 offen offset:3072 nt lds
  v_sub_f32 v34, v32, v35
  v_sub_f32 v40, v40, v35
  v_sub_f32 v41, v41, v35
  v_sub_f32 v42, v42, v35
  v_sub_f32 v43, v43, v35
  v_exp_f32 v34, v34
  v_exp_f32 v40, v40
  v_exp_f32 v41, v41
  v_exp_f32 v42, v42
  v_exp_f32 v43, v43
  v_mov_b32 v32, v35
  v_add_f32 v22, v40, v41
  v_add_f32 v23, v42, v43
  v_cvt_pk_bf16_f32 v36, v40, v41
  v_cvt_pk_bf16_f32 v37, v42, v43
  v_add_f32 v22, v22, v23
  v_fma_f32 v33, v33, v34, v22
  s_cmp_ge_u32 s70, 13
  s_cbranch_scc1 L_halfskip_5
  s_waitcnt vmcnt(6)
  s_add_u32 m0, s69, 4096
  s_nop 0
  buffer_load_dwordx4 v6, s[8:11], s68 offen offset:0 nt lds
  s_waitcnt vmcnt(6)
  buffer_load_dwordx4 v7, s[8:11], s68 offen offset:1024 nt lds
  s_waitcnt vmcnt(6)
  buffer_load_dwordx4 v8, s[8:11], s68 offen offset:2048 nt lds
  s_waitcnt vmcnt(6)
  buffer_load_dwordx4 v9, s[8:11], s68 offen offset:3072 nt lds
L_halfskip_5:
  s_waitcnt vmcnt(12)
  ds_read_b64_tr_b16 v[108:109], v14 offset:0
  ds_read_b64_tr_b16 v[110:111], v15 offset:0
  ds_read_b64_tr_b16 v[112:113], v16 offset:0
  ds_read_b64_tr_b16 v[114:115], v17 offset:0
  ds_read_b64_tr_b16 v[116:117], v18 offset:0
  ds_read_b64_tr_b16 v[118:119], v19 offset:0
  ds_read_b64_tr_b16 v[120:121], v20 offset:0
  ds_read_b64_tr_b16 v[122:123], v21 offset:0
  v_cmp_neq_f32 vcc, 1.0, v34
  s_cbranch_vccz L_norescale_6
  v_mul_f32 v140, v140, v34
  v_mul_f32 v141, v141, v34
  v_mul_f32 v142, v142, v34
  v_mul_f32 v143, v143, v34
  v_mul_f32 v144, v144, v34
  v_mul_f32 v145, v145, v34
  v_mul_f32 v146, v146, v34
  v_mul_f32 v147, v147, v34
  v_mul_f32 v148, v148, v34
  v_mul_f32 v149, v149, v34
  v_mul_f32 v150, v150, v34
  v_mul_f32 v151, v151, v34
  v_mul_f32 v152, v152, v34
  v_mul_f32 v153, v153, v34
  v_mul_f32 v154, v154, v34
  v_mul_f32 v155, v155, v34
  v_mul_f32 v156, v156, v34
  v_mul_f32 v157, v157, v34
  v_mul_f32 v158, v158, v34
  v_mul_f32 v159, v159, v34
  v_mul_f32 v160, v160, v34
  v_mul_f32 v161, v161, v34
  v_mul_f32 v162, v162, v34
  v_mul_f32 v163, v163, v34
  v_mul_f32 v164, v164, v34
  v_mul_f32 v165, v165, v34
  v_mul_f32 v166, v166, v34
  v_mul_f32 v167, v167, v34
  v_mul_f32 v168, v168, v34
  v_mul_f32 v169, v169, v34
  v_mul_f32 v170, v170, v34
  v_mul_f32 v171, v171, v34
  v_mul_f32 v172, v172, v34
  v_mul_f32 v173, v173, v34
  v_mul_f32 v174, v174, v34
  v_mul_f32 v175, v175, v34
  v_mul_f32 v176, v176, v34
  v_mul_f32 v177, v177, v34
  v_mul_f32 v178, v178, v34
  v_mul_f32 v179, v179, v34
  v_mul_f32 v180, v180, v34
  v_mul_f32 v181, v181, v34
  v_mul_f32 v182, v182, v34
  v_mul_f32 v183, v183, v34
  v_mul_f32 v184, v184, v34
  v_mul_f32 v185, v185, v34
  v_mul_f32 v186, v186, v34
  v_mul_f32 v187, v187, v34
  v_mul_f32 v188, v188, v34
  v_mul_f32 v189, v189, v34
  v_mul_f32 v190, v190, v34
  v_mul_f32 v191, v191, v34
  v_mul_f32 v192, v192, v34
  v_mul_f32 v193, v193, v34
  v_mul_f32 v194, v194, v34
  v_mul_f32 v195, v195, v34
  v_mul_f32 v196, v196, v34
  v_mul_f32 v197, v197, v34
  v_mul_f32 v198, v198, v34
  v_mul_f32 v199, v199, v34
  v_mul_f32 v200, v200, v34
  v_mul_f32 v201, v201, v34
  v_mul_f32 v202, v202, v34
  v_mul_f32 v203, v203, v34
L_norescale_6:
  s_nop 1
  s_waitcnt lgkmcnt(7)
  v_mfma_f32_16x16x16_bf16 v[140:143], v[108:109], v[36:37], v[140:143]
  ds_read_b64_tr_b16 v[124:125], v14 offset:256
  s_waitcnt lgkmcnt(7)
  v_mfma_f32_16x16x16_bf16 v[144:147], v[110:111], v[36:37], v[144:147]
  ds_read_b64_tr_b16 v[126:127], v15 offset:256
  s_waitcnt lgkmcnt(7)
  v_mfma_f32_16x16x16_bf16 v[148:151], v[112:113], v[36:37], v[148:151]
  ds_read_b64_tr_b16 v[128:129], v16 offset:256
  s_waitcnt lgkmcnt(7)
  v_mfma_f32_16x16x16_bf16 v[152:155], v[114:115], v[36:37], v[152:155]
  ds_read_b64_tr_b16 v[130:131], v17 offset:256
  s_waitcnt lgkmcnt(7)
  v_mfma_f32_16x16x16_bf16 v[156:159], v[116:117], v[36:37], v[156:159]
  ds_read_b64_tr_b16 v[132:133], v18 offset:256
  s_waitcnt lgkmcnt(7)
  v_mfma_f32_16x16x16_bf16 v[160:163], v[118:119], v[36:37], v[160:163]
  ds_read_b64_tr_b16 v[134:135], v19 offset:256
  s_waitcnt lgkmcnt(7)
  v_mfma_f32_16x16x16_bf16 v[164:167], v[120:121], v[36:37], v[164:167]
  ds_read_b64_tr_b16 v[136:137], v20 offset:256
  s_waitcnt lgkmcnt(7)
  v_mfma_f32_16x16x16_bf16 v[168:171], v[122:123], v[36:37], v[168:171]
  ds_read_b64_tr_b16 v[138:139], v21 offset:256
  s_waitcnt lgkmcnt(7)
  v_mfma_f32_16x16x16_bf16 v[172:175], v[124:125], v[36:37], v[172:175]
  s_waitcnt lgkmcnt(6)
  v_mfma_f32_16x16x16_bf16 v[176:179], v[126:127], v[36:37], v[176:179]
  s_waitcnt lgkmcnt(5)
  v_mfma_f32_16x16x16_bf16 v[180:183], v[128:129], v[36:37], v[180:183]
  s_waitcnt lgkmcnt(4)
  v_mfma_f32_16x16x16_bf16 v[184:187], v[130:131], v[36:37], v[184:187]
  s_waitcnt lgkmcnt(3)
  v_mfma_f32_16x16x16_bf16 v[188:191], v[132:133], v[36:37], v[188:191]
  s_waitcnt lgkmcnt(2)
  v_mfma_f32_16x16x16_bf16 v[192:195], v[134:135], v[36:37], v[192:195]
  s_waitcnt lgkmcnt(1)
  v_mfma_f32_16x16x16_bf16 v[196:199], v[136:137], v[36:37], v[196:199]
  s_waitcnt lgkmcnt(0)
  v_mfma_f32_16x16x16_bf16 v[200:203], v[138:139], v[36:37], v[200:203]
  s_waitcnt vmcnt(6)
  s_add_u32 m0, s69, 8192
  s_nop 0
  buffer_load_dwordx4 v2, s[12:15], s68 offen offset:0 nt lds
  s_waitcnt vmcnt(6)
  buffer_load_dwordx4 v3, s[12:15], s68 offen offset:1024 nt lds
  s_waitcnt vmcnt(6)
  buffer_load_dwordx4 v4, s[12:15], s68 offen offset:2048 nt lds
  s_waitcnt vmcnt(6)
  buffer_load_dwordx4 v5, s[12:15], s68 offen offset:3072 nt lds
  s_cmp_ge_u32 s70, 13
  s_cbranch_scc1 L_halfskip_7
  s_waitcnt vmcnt(6)
  s_add_u32 m0, s69, 12288
  s_nop 0
  buffer_load_dwordx4 v6, s[12:15], s68 offen offset:0 nt lds
  s_waitcnt vmcnt(6)
  buffer_load_dwordx4 v7, s[12:15], s68 offen offset:1024 nt lds
  s_waitcnt vmcnt(6)
  buffer_load_dwordx4 v8, s[12:15], s68 offen offset:2048 nt lds
  s_waitcnt vmcnt(6)
  buffer_load_dwordx4 v9, s[12:15], s68 offen offset:3072 nt lds
L_halfskip_7:
  v_xor_b32 v14, 0x4000, v14
  v_xor_b32 v15, 0x4000, v15
  v_xor_b32 v16, 0x4000, v16
  v_xor_b32 v17, 0x4000, v17
  v_xor_b32 v18, 0x4000, v18
  v_xor_b32 v19, 0x4000, v19
  v_xor_b32 v20, 0x4000, v20
  v_xor_b32 v21, 0x4000, v21
  s_xor_b32 s69, s69, 0x4000
  s_add_u32 s70, s70, 1
  s_cmp_lt_u32 s70, 13
  s_cbranch_scc1 L_static_8
  s_waitcnt vmcnt(8)
  v_readfirstlane_b32 s4, v39
  s_nop 0
  s_and_b32 s5, s4, 3
  s_lshl_b32 s5, s5, 20
  s_lshr_b32 s6, s4, 2
  s_lshl_b32 s6, s6, 12
  s_add_u32 s5, s5, s6
  s_add_u32 s5, s5, 851968
  s_add_u32 s68, s98, s5
  s_cmp_lt_u32 s4, 192
  s_cbranch_scc1 parallel_sum__gqa_block_cached__glu_gated_geglu__decode_kernel_loop
  s_branch parallel_sum__gqa_block_cached__glu_gated_geglu__decode_kernel_epi
L_static_8:
  s_lshl_b32 s4, s70, 5
  s_add_u32 s4, s4, s99
L_idx_9:
  s_lshl_b32 s5, s70, 16
  s_add_u32 s5, s5, s96
  s_add_u32 s68, s98, s5
  s_cmp_lt_u32 s4, 512
  s_cbranch_scc1 parallel_sum__gqa_block_cached__glu_gated_geglu__decode_kernel_loop
parallel_sum__gqa_block_cached__glu_gated_geglu__decode_kernel_epi:
  s_cmp_ge_u32 s70, 15
  s_cbranch_scc0 L_nomask_10
  v_mov_b32 v38, v237
L_nomask_10:
  s_waitcnt vmcnt(12)
  ds_read_b128 v[76:79], v10 offset:0
  ds_read_b128 v[80:83], v11 offset:0
  ds_read_b128 v[84:87], v12 offset:0
  ds_read_b128 v[88:91], v13 offset:0
  ds_read_b128 v[92:95], v10 offset:256
  ds_read_b128 v[96:99], v11 offset:256
  ds_read_b128 v[100:103], v12 offset:256
  ds_read_b128 v[104:107], v13 offset:256
  s_waitcnt lgkmcnt(7)
  v_mfma_f32_16x16x32_bf16 v[40:43], v[76:79], v[44:47], 0
  s_waitcnt lgkmcnt(6)
  v_mfma_f32_16x16x32_bf16 v[40:43], v[80:83], v[48:51], v[40:43]
  s_waitcnt lgkmcnt(5)
  v_mfma_f32_16x16x32_bf16 v[40:43], v[84:87], v[52:55], v[40:43]
  s_waitcnt lgkmcnt(4)
  v_mfma_f32_16x16x32_bf16 v[40:43], v[88:91], v[56:59], v[40:43]
  s_waitcnt lgkmcnt(3)
  v_mfma_f32_16x16x32_bf16 v[40:43], v[92:95], v[60:63], v[40:43]
  s_waitcnt lgkmcnt(2)
  v_mfma_f32_16x16x32_bf16 v[40:43], v[96:99], v[64:67], v[40:43]
  s_waitcnt lgkmcnt(1)
  v_mfma_f32_16x16x32_bf16 v[40:43], v[100:103], v[68:71], v[40:43]
  s_waitcnt lgkmcnt(0)
  v_mfma_f32_16x16x32_bf16 v[40:43], v[104:107], v[72:75], v[40:43]
  v_xor_b32 v10, 0x4000, v10
  v_xor_b32 v11, 0x4000, v11
  v_xor_b32 v12, 0x4000, v12
  v_xor_b32 v13, 0x4000, v13
  s_nop 3
  v_cvt_pk_bf16_f32 v22, v40, v41
  v_cvt_pk_bf16_f32 v23, v42, v43
  v_lshlrev_b32 v40, 16, v22
  v_and_b32 v41, 0xffff0000, v22
  v_lshlrev_b32 v42, 16, v23
  v_and_b32 v43, 0xffff0000, v23
  v_fma_f32 v40, v40, s67, v38
  v_fma_f32 v41, v41, s67, v38
  v_fma_f32 v42, v42, s67, v38
  v_fma_f32 v43, v43, s67, v38
  v_max3_f32 v35, v40, v41, v42
  v_max3_f32 v35, v35, v43, v32
  v_mov_b32 v22, v35
  s_nop 1
  v_permlane16_swap_b32 v22, v35
  s_nop 0
  v_max_f32 v35, v35, v22
  v_mov_b32 v22, v35
  s_nop 1
  v_permlane32_swap_b32 v22, v35
  s_nop 0
  v_max_f32 v35, v35, v22
  v_sub_f32 v34, v32, v35
  v_sub_f32 v40, v40, v35
  v_sub_f32 v41, v41, v35
  v_sub_f32 v42, v42, v35
  v_sub_f32 v43, v43, v35
  v_exp_f32 v34, v34
  v_exp_f32 v40, v40
  v_exp_f32 v41, v41
  v_exp_f32 v42, v42
  v_exp_f32 v43, v43
  v_mov_b32 v32, v35
  v_add_f32 v22, v40, v41
  v_add_f32 v23, v42, v43
  v_cvt_pk_bf16_f32 v36, v40, v41
  v_cvt_pk_bf16_f32 v37, v42, v43
  v_add_f32 v22, v22, v23
  v_fma_f32 v33, v33, v34, v22
  s_waitcnt vmcnt(8)
  ds_read_b64_tr_b16 v[108:109], v14 offset:0
  ds_read_b64_tr_b16 v[110:111], v15 offset:0
  ds_read_b64_tr_b16 v[112:113], v16 offset:0
  ds_read_b64_tr_b16 v[114:115], v17 offset:0
  ds_read_b64_tr_b16 v[116:117], v18 offset:0
  ds_read_b64_tr_b16 v[118:119], v19 offset:0
  ds_read_b64_tr_b16 v[120:121], v20 offset:0
  ds_read_b64_tr_b16 v[122:123], v21 offset:0
  v_cmp_neq_f32 vcc, 1.0, v34
  s_cbranch_vccz L_norescale_11
  v_mul_f32 v140, v140, v34
  v_mul_f32 v141, v141, v34
  v_mul_f32 v142, v142, v34
  v_mul_f32 v143, v143, v34
  v_mul_f32 v144, v144, v34
  v_mul_f32 v145, v145, v34
  v_mul_f32 v146, v146, v34
  v_mul_f32 v147, v147, v34
  v_mul_f32 v148, v148, v34
  v_mul_f32 v149, v149, v34
  v_mul_f32 v150, v150, v34
  v_mul_f32 v151, v151, v34
  v_mul_f32 v152, v152, v34
  v_mul_f32 v153, v153, v34
  v_mul_f32 v154, v154, v34
  v_mul_f32 v155, v155, v34
  v_mul_f32 v156, v156, v34
  v_mul_f32 v157, v157, v34
  v_mul_f32 v158, v158, v34
  v_mul_f32 v159, v159, v34
  v_mul_f32 v160, v160, v34
  v_mul_f32 v161, v161, v34
  v_mul_f32 v162, v162, v34
  v_mul_f32 v163, v163, v34
  v_mul_f32 v164, v164, v34
  v_mul_f32 v165, v165, v34
  v_mul_f32 v166, v166, v34
  v_mul_f32 v167, v167, v34
  v_mul_f32 v168, v168, v34
  v_mul_f32 v169, v169, v34
  v_mul_f32 v170, v170, v34
  v_mul_f32 v171, v171, v34
  v_mul_f32 v172, v172, v34
  v_mul_f32 v173, v173, v34
  v_mul_f32 v174, v174, v34
  v_mul_f32 v175, v175, v34
  v_mul_f32 v176, v176, v34
  v_mul_f32 v177, v177, v34
  v_mul_f32 v178, v178, v34
  v_mul_f32 v179, v179, v34
  v_mul_f32 v180, v180, v34
  v_mul_f32 v181, v181, v34
  v_mul_f32 v182, v182, v34
  v_mul_f32 v183, v183, v34
  v_mul_f32 v184, v184, v34
  v_mul_f32 v185, v185, v34
  v_mul_f32 v186, v186, v34
  v_mul_f32 v187, v187, v34
  v_mul_f32 v188, v188, v34
  v_mul_f32 v189, v189, v34
  v_mul_f32 v190, v190, v34
  v_mul_f32 v191, v191, v34
  v_mul_f32 v192, v192, v34
  v_mul_f32 v193, v193, v34
  v_mul_f32 v194, v194, v34
  v_mul_f32 v195, v195, v34
  v_mul_f32 v196, v196, v34
  v_mul_f32 v197, v197, v34
  v_mul_f32 v198, v198, v34
  v_mul_f32 v199, v199, v34
  v_mul_f32 v200, v200, v34
  v_mul_f32 v201, v201, v34
  v_mul_f32 v202, v202, v34
  v_mul_f32 v203, v203, v34
L_norescale_11:
  s_nop 1
  s_waitcnt lgkmcnt(7)
  v_mfma_f32_16x16x16_bf16 v[140:143], v[108:109], v[36:37], v[140:143]
  ds_read_b64_tr_b16 v[124:125], v14 offset:256
  s_waitcnt lgkmcnt(7)
  v_mfma_f32_16x16x16_bf16 v[144:147], v[110:111], v[36:37], v[144:147]
  ds_read_b64_tr_b16 v[126:127], v15 offset:256
  s_waitcnt lgkmcnt(7)
  v_mfma_f32_16x16x16_bf16 v[148:151], v[112:113], v[36:37], v[148:151]
  ds_read_b64_tr_b16 v[128:129], v16 offset:256
  s_waitcnt lgkmcnt(7)
  v_mfma_f32_16x16x16_bf16 v[152:155], v[114:115], v[36:37], v[152:155]
  ds_read_b64_tr_b16 v[130:131], v17 offset:256
  s_waitcnt lgkmcnt(7)
  v_mfma_f32_16x16x16_bf16 v[156:159], v[116:117], v[36:37], v[156:159]
  ds_read_b64_tr_b16 v[132:133], v18 offset:256
  s_waitcnt lgkmcnt(7)
  v_mfma_f32_16x16x16_bf16 v[160:163], v[118:119], v[36:37], v[160:163]
  ds_read_b64_tr_b16 v[134:135], v19 offset:256
  s_waitcnt lgkmcnt(7)
  v_mfma_f32_16x16x16_bf16 v[164:167], v[120:121], v[36:37], v[164:167]
  ds_read_b64_tr_b16 v[136:137], v20 offset:256
  s_waitcnt lgkmcnt(7)
  v_mfma_f32_16x16x16_bf16 v[168:171], v[122:123], v[36:37], v[168:171]
  ds_read_b64_tr_b16 v[138:139], v21 offset:256
  s_waitcnt lgkmcnt(7)
  v_mfma_f32_16x16x16_bf16 v[172:175], v[124:125], v[36:37], v[172:175]
  s_waitcnt lgkmcnt(6)
  v_mfma_f32_16x16x16_bf16 v[176:179], v[126:127], v[36:37], v[176:179]
  s_waitcnt lgkmcnt(5)
  v_mfma_f32_16x16x16_bf16 v[180:183], v[128:129], v[36:37], v[180:183]
  s_waitcnt lgkmcnt(4)
  v_mfma_f32_16x16x16_bf16 v[184:187], v[130:131], v[36:37], v[184:187]
  s_waitcnt lgkmcnt(3)
  v_mfma_f32_16x16x16_bf16 v[188:191], v[132:133], v[36:37], v[188:191]
  s_waitcnt lgkmcnt(2)
  v_mfma_f32_16x16x16_bf16 v[192:195], v[134:135], v[36:37], v[192:195]
  s_waitcnt lgkmcnt(1)
  v_mfma_f32_16x16x16_bf16 v[196:199], v[136:137], v[36:37], v[196:199]
  s_waitcnt lgkmcnt(0)
  v_mfma_f32_16x16x16_bf16 v[200:203], v[138:139], v[36:37], v[200:203]
  v_xor_b32 v14, 0x4000, v14
  v_xor_b32 v15, 0x4000, v15
  v_xor_b32 v16, 0x4000, v16
  v_xor_b32 v17, 0x4000, v17
  v_xor_b32 v18, 0x4000, v18
  v_xor_b32 v19, 0x4000, v19
  v_xor_b32 v20, 0x4000, v20
  v_xor_b32 v21, 0x4000, v21
  s_cmp_ge_u32 s70, 14
  s_cbranch_scc0 L_nomask_12
  v_mov_b32 v38, v237
L_nomask_12:
  s_waitcnt vmcnt(4)
  ds_read_b128 v[76:79], v10 offset:0
  ds_read_b128 v[80:83], v11 offset:0
  ds_read_b128 v[84:87], v12 offset:0
  ds_read_b128 v[88:91], v13 offset:0
  ds_read_b128 v[92:95], v10 offset:256
  ds_read_b128 v[96:99], v11 offset:256
  ds_read_b128 v[100:103], v12 offset:256
  ds_read_b128 v[104:107], v13 offset:256
  s_waitcnt lgkmcnt(7)
  v_mfma_f32_16x16x32_bf16 v[40:43], v[76:79], v[44:47], 0
  s_waitcnt lgkmcnt(6)
  v_mfma_f32_16x16x32_bf16 v[40:43], v[80:83], v[48:51], v[40:43]
  s_waitcnt lgkmcnt(5)
  v_mfma_f32_16x16x32_bf16 v[40:43], v[84:87], v[52:55], v[40:43]
  s_waitcnt lgkmcnt(4)
  v_mfma_f32_16x16x32_bf16 v[40:43], v[88:91], v[56:59], v[40:43]
  s_waitcnt lgkmcnt(3)
  v_mfma_f32_16x16x32_bf16 v[40:43], v[92:95], v[60:63], v[40:43]
  s_waitcnt lgkmcnt(2)
  v_mfma_f32_16x16x32_bf16 v[40:43], v[96:99], v[64:67], v[40:43]
  s_waitcnt lgkmcnt(1)
  v_mfma_f32_16x16x32_bf16 v[40:43], v[100:103], v[68:71], v[40:43]
  s_waitcnt lgkmcnt(0)
  v_mfma_f32_16x16x32_bf16 v[40:43], v[104:107], v[72:75], v[40:43]
  v_xor_b32 v10, 0x4000, v10
  v_xor_b32 v11, 0x4000, v11
  v_xor_b32 v12, 0x4000, v12
  v_xor_b32 v13, 0x4000, v13
  s_nop 3
  v_cvt_pk_bf16_f32 v22, v40, v41
  v_cvt_pk_bf16_f32 v23, v42, v43
  v_lshlrev_b32 v40, 16, v22
  v_and_b32 v41, 0xffff0000, v22
  v_lshlrev_b32 v42, 16, v23
  v_and_b32 v43, 0xffff0000, v23
  v_fma_f32 v40, v40, s67, v38
  v_fma_f32 v41, v41, s67, v38
  v_fma_f32 v42, v42, s67, v38
  v_fma_f32 v43, v43, s67, v38
  v_max3_f32 v35, v40, v41, v42
  v_max3_f32 v35, v35, v43, v32
  v_mov_b32 v22, v35
  s_nop 1
  v_permlane16_swap_b32 v22, v35
  s_nop 0
  v_max_f32 v35, v35, v22
  v_mov_b32 v22, v35
  s_nop 1
  v_permlane32_swap_b32 v22, v35
  s_nop 0
  v_max_f32 v35, v35, v22
  v_sub_f32 v34, v32, v35
  v_sub_f32 v40, v40, v35
  v_sub_f32 v41, v41, v35
  v_sub_f32 v42, v42, v35
  v_sub_f32 v43, v43, v35
  v_exp_f32 v34, v34
  v_exp_f32 v40, v40
  v_exp_f32 v41, v41
  v_exp_f32 v42, v42
  v_exp_f32 v43, v43
  v_mov_b32 v32, v35
  v_add_f32 v22, v40, v41
  v_add_f32 v23, v42, v43
  v_cvt_pk_bf16_f32 v36, v40, v41
  v_cvt_pk_bf16_f32 v37, v42, v43
  v_add_f32 v22, v22, v23
  v_fma_f32 v33, v33, v34, v22
  v_mov_b32 v22, v33
  s_nop 1
  v_permlane16_swap_b32 v22, v33
  s_nop 0
  v_add_f32 v33, v33, v22
  v_mov_b32 v22, v33
  s_nop 1
  v_permlane32_swap_b32 v22, v33
  s_nop 0
  v_add_f32 v33, v33, v22
  v_and_b32 v206, 15, v1
  v_lshlrev_b32 v206, 3, v206
  v_add_u32 v206, s66, v206
  v_mov_b32 v208, v32
  v_mov_b32 v209, v33
  v_mov_b32 v210, 163200
  v_mov_b32 v211, 1
  s_mov_b64 exec, 3
  ds_write_b64 v206, v[208:209] offset:2048
  s_mov_b64 exec, -1
  v_and_b32 v212, 15, v1
  v_lshlrev_b32 v204, 10, v212
  v_lshrrev_b32 v205, 4, v1
  v_lshl_add_u32 v204, v205, 4, v204
  v_lshlrev_b32 v205, 4, v1
  v_add_u32 v205, 16384, v205
  v_cmp_gt_u32 vcc, 2, v212
  s_waitcnt lgkmcnt(0)
  s_nop 0
  v_cndmask_b32 v204, v205, v204, vcc
  v_add_u32 v204, s66, v204
  s_mov_b64 exec, 1
  ds_add_u32 v210, v211 offset:16
  s_mov_b64 exec, -1
  s_waitcnt vmcnt(0)
  s_waitcnt lgkmcnt(0)
  ds_read_b64_tr_b16 v[108:109], v14 offset:0
  ds_read_b64_tr_b16 v[110:111], v15 offset:0
  ds_read_b64_tr_b16 v[112:113], v16 offset:0
  ds_read_b64_tr_b16 v[114:115], v17 offset:0
  ds_read_b64_tr_b16 v[116:117], v18 offset:0
  ds_read_b64_tr_b16 v[118:119], v19 offset:0
  ds_read_b64_tr_b16 v[120:121], v20 offset:0
  ds_read_b64_tr_b16 v[122:123], v21 offset:0
  ds_read_b64_tr_b16 v[124:125], v14 offset:256
  ds_read_b64_tr_b16 v[126:127], v15 offset:256
  ds_read_b64_tr_b16 v[128:129], v16 offset:256
  ds_read_b64_tr_b16 v[130:131], v17 offset:256
  v_cmp_neq_f32 vcc, 1.0, v34
  s_cbranch_vccz L_norescale_13
  v_mul_f32 v140, v140, v34
  v_mul_f32 v141, v141, v34
  v_mul_f32 v142, v142, v34
  v_mul_f32 v143, v143, v34
  v_mul_f32 v144, v144, v34
  v_mul_f32 v145, v145, v34
  v_mul_f32 v146, v146, v34
  v_mul_f32 v147, v147, v34
  v_mul_f32 v148, v148, v34
  v_mul_f32 v149, v149, v34
  v_mul_f32 v150, v150, v34
  v_mul_f32 v151, v151, v34
  v_mul_f32 v152, v152, v34
  v_mul_f32 v153, v153, v34
  v_mul_f32 v154, v154, v34
  v_mul_f32 v155, v155, v34
  v_mul_f32 v156, v156, v34
  v_mul_f32 v157, v157, v34
  v_mul_f32 v158, v158, v34
  v_mul_f32 v159, v159, v34
  v_mul_f32 v160, v160, v34
  v_mul_f32 v161, v161, v34
  v_mul_f32 v162, v162, v34
  v_mul_f32 v163, v163, v34
  v_mul_f32 v164, v164, v34
  v_mul_f32 v165, v165, v34
  v_mul_f32 v166, v166, v34
  v_mul_f32 v167, v167, v34
  v_mul_f32 v168, v168, v34
  v_mul_f32 v169, v169, v34
  v_mul_f32 v170, v170, v34
  v_mul_f32 v171, v171, v34
  v_mul_f32 v172, v172, v34
  v_mul_f32 v173, v173, v34
  v_mul_f32 v174, v174, v34
  v_mul_f32 v175, v175, v34
  v_mul_f32 v176, v176, v34
  v_mul_f32 v177, v177, v34
  v_mul_f32 v178, v178, v34
  v_mul_f32 v179, v179, v34
  v_mul_f32 v180, v180, v34
  v_mul_f32 v181, v181, v34
  v_mul_f32 v182, v182, v34
  v_mul_f32 v183, v183, v34
  v_mul_f32 v184, v184, v34
  v_mul_f32 v185, v185, v34
  v_mul_f32 v186, v186, v34
  v_mul_f32 v187, v187, v34
  v_mul_f32 v188, v188, v34
  v_mul_f32 v189, v189, v34
  v_mul_f32 v190, v190, v34
  v_mul_f32 v191, v191, v34
  v_mul_f32 v192, v192, v34
  v_mul_f32 v193, v193, v34
  v_mul_f32 v194, v194, v34
  v_mul_f32 v195, v195, v34
  v_mul_f32 v196, v196, v34
  v_mul_f32 v197, v197, v34
  v_mul_f32 v198, v198, v34
  v_mul_f32 v199, v199, v34
  v_mul_f32 v200, v200, v34
  v_mul_f32 v201, v201, v34
  v_mul_f32 v202, v202, v34
  v_mul_f32 v203, v203, v34
L_norescale_13:
  s_nop 1
  s_waitcnt lgkmcnt(11)
  v_mfma_f32_16x16x16_bf16 v[140:143], v[108:109], v[36:37], v[140:143]
  ds_read_b64_tr_b16 v[132:133], v18 offset:256
  s_waitcnt lgkmcnt(11)
  v_mfma_f32_16x16x16_bf16 v[144:147], v[110:111], v[36:37], v[144:147]
  ds_read_b64_tr_b16 v[134:135], v19 offset:256
  s_waitcnt lgkmcnt(11)
  v_mfma_f32_16x16x16_bf16 v[148:151], v[112:113], v[36:37], v[148:151]
  ds_read_b64_tr_b16 v[136:137], v20 offset:256
  s_waitcnt lgkmcnt(11)
  v_mfma_f32_16x16x16_bf16 v[152:155], v[114:115], v[36:37], v[152:155]
  ds_read_b64_tr_b16 v[138:139], v21 offset:256
  s_waitcnt lgkmcnt(11)
  v_mfma_f32_16x16x16_bf16 v[156:159], v[116:117], v[36:37], v[156:159]
  ds_write_b128 v204, v[140:143] offset:0
  s_waitcnt lgkmcnt(11)
  v_mfma_f32_16x16x16_bf16 v[160:163], v[118:119], v[36:37], v[160:163]
  ds_write_b128 v204, v[144:147] offset:64
  s_waitcnt lgkmcnt(11)
  v_mfma_f32_16x16x16_bf16 v[164:167], v[120:121], v[36:37], v[164:167]
  ds_write_b128 v204, v[148:151] offset:128
  s_waitcnt lgkmcnt(11)
  v_mfma_f32_16x16x16_bf16 v[168:171], v[122:123], v[36:37], v[168:171]
  ds_write_b128 v204, v[152:155] offset:192
  s_waitcnt lgkmcnt(11)
  v_mfma_f32_16x16x16_bf16 v[172:175], v[124:125], v[36:37], v[172:175]
  ds_write_b128 v204, v[156:159] offset:256
  s_waitcnt lgkmcnt(11)
  v_mfma_f32_16x16x16_bf16 v[176:179], v[126:127], v[36:37], v[176:179]
  ds_write_b128 v204, v[160:163] offset:320
  s_waitcnt lgkmcnt(11)
  v_mfma_f32_16x16x16_bf16 v[180:183], v[128:129], v[36:37], v[180:183]
  ds_write_b128 v204, v[164:167] offset:384
  s_waitcnt lgkmcnt(11)
  v_mfma_f32_16x16x16_bf16 v[184:187], v[130:131], v[36:37], v[184:187]
  ds_write_b128 v204, v[168:171] offset:448
  s_waitcnt lgkmcnt(11)
  v_mfma_f32_16x16x16_bf16 v[188:191], v[132:133], v[36:37], v[188:191]
  ds_write_b128 v204, v[172:175] offset:512
  s_waitcnt lgkmcnt(11)
  v_mfma_f32_16x16x16_bf16 v[192:195], v[134:135], v[36:37], v[192:195]
  ds_write_b128 v204, v[176:179] offset:576
  s_waitcnt lgkmcnt(11)
  v_mfma_f32_16x16x16_bf16 v[196:199], v[136:137], v[36:37], v[196:199]
  ds_write_b128 v204, v[180:183] offset:640
  s_waitcnt lgkmcnt(11)
  v_mfma_f32_16x16x16_bf16 v[200:203], v[138:139], v[36:37], v[200:203]
  ds_write_b128 v204, v[184:187] offset:704
  ds_write_b128 v204, v[188:191] offset:768
  ds_write_b128 v204, v[192:195] offset:832
  s_nop 1
  ds_write_b128 v204, v[196:199] offset:896
  s_nop 1
  ds_write_b128 v204, v[200:203] offset:960
  s_waitcnt lgkmcnt(0)
  s_barrier
  s_endpgm
parallel_sum__gqa_block_cached__glu_gated_geglu__decode_kernel_aux:
  s_sub_u32 s3, s3, 4
  v_lshrrev_b32 v26, 3, v1
  v_and_b32 v27, 7, v1
  v_lshlrev_b32 v27, 4, v27
  v_lshl_add_u32 v28, v26, 13, v27
  s_movk_i32 s32, 3584
  v_mul_lo_u32 v29, v26, s32
  v_add_u32 v29, v29, v27
  v_lshlrev_b32 v25, 4, v1
  s_and_b32 s33, s2, 3
  s_lshr_b32 s34, s2, 2
  s_min_u32 s35, s34, 55
  s_cmp_ge_u32 s35, 28
  s_cselect_b32 s36, 28, 0
  s_cselect_b32 s37, 1, 0
  s_sub_u32 s35, s35, s36
  s_mul_i32 s38, s33, 112
  s_mul_i32 s39, s3, 28
  s_add_u32 s38, s38, s39
  s_lshl_b32 s4, s38, 13
  s_lshl_b32 s5, s34, 7
  s_add_u32 s4, s4, s5
  s_mul_i32 s6, s38, 3584
  s_lshl_b32 s5, s35, 7
  s_add_u32 s6, s6, s5
  s_mul_i32 s7, s3, 3584
  s_mul_i32 s39, s3, 896
  v_mov_b32 v44, 0
  v_mov_b32 v45, 0
  v_mov_b32 v46, 0
  v_mov_b32 v47, 0
  v_mov_b32 v236, 163200
  v_mov_b32 v237, 1
  v_mov_b32 v234, v29
  s_cmp_eq_u32 s3, 0
  s_cbranch_scc0 L_nozero_14
  s_mov_b64 exec, 1
  ds_write_b64 v236, v[44:45]
  ds_write_b64 v236, v[44:45] offset:8
  ds_write_b64 v236, v[44:45] offset:16
  s_mov_b64 exec, -1
L_nozero_14:
  s_waitcnt lgkmcnt(0)
  s_load_dword s64, s[62:63], 0
  s_mov_b32 s28, s40
  s_and_b32 s29, s41, 0xffff
  s_mov_b32 s30, 3584
  s_mov_b32 s31, 0x20000
  s_mov_b32 s16, s62
  s_and_b32 s17, s63, 0xffff
  s_mov_b32 s18, 2695168
  s_mov_b32 s19, 0x20000
  s_mov_b32 s20, s46
  s_and_b32 s21, s47, 0xffff
  s_mov_b32 s22, 3670016
  s_mov_b32 s23, 0x20000
  s_and_b32 s36, s2, 31
  s_cmp_lt_u32 s36, 4
  s_cbranch_scc0 L_noinit_15
  s_cmp_eq_u32 s3, 0
  s_cbranch_scc0 L_noinit_15
  s_lshl_b32 s36, s36, 3
  s_lshr_b32 s38, s2, 5
  s_add_u32 s36, s36, s38
  s_lshl_b32 s36, s36, 8
  s_add_u32 s36, s36, 4096
  s_mov_b64 exec, 1
  buffer_store_dword v44, v44, s[16:19], s36 offen sc1
  s_mov_b64 exec, -1
L_noinit_15:
  s_mov_b32 exec_lo, 0xffffffff
  s_mov_b32 exec_hi, 0xffffff
  buffer_load_dwordx4 v[44:47], v25, s[28:31], s39 offen nt
  s_mov_b64 exec, -1
  s_barrier
  s_add_u32 m0, s7, 131072
  s_nop 0
  buffer_load_dwordx4 v28, s[20:23], s4 offen nt lds
  s_add_u32 s4, s4, 65536
  s_add_u32 m0, s7, 132096
  s_nop 0
  buffer_load_dwordx4 v28, s[20:23], s4 offen nt lds
  s_add_u32 s4, s4, 65536
  s_add_u32 m0, s7, 133120
  s_nop 0
  buffer_load_dwordx4 v28, s[20:23], s4 offen nt lds
  s_add_u32 s4, s4, 65536
  s_add_u32 m0, s7, 134144
  s_mov_b32 exec_lo, 0xffffffff
  s_mov_b32 exec_hi, 0x0
  buffer_load_dwordx4 v28, s[20:23], s4 offen nt lds
  s_mov_b64 exec, -1
  s_cmp_eq_u32 s37, 0
  s_cselect_b32 s24, s52, s54
  s_cselect_b32 s25, s53, s55
  s_and_b32 s25, s25, 0xffff
  s_mov_b32 s26, 1605632
  s_mov_b32 s27, 0x20000
  v_lshrrev_b32 v22, 2, v1
  v_lshlrev_b32 v22, 7, v22
  v_and_b32 v23, 3, v1
  v_lshl_add_u32 v22, v23, 3, v22
  s_lshl_b32 s4, s3, 5
  s_add_u32 s4, s4, 131072
  v_add_u32 v228, s4, v22
  v_mul_u32_u24 v23, 224, v23
  v_lshrrev_b32 v24, 4, v1
  v_lshl_add_u32 v23, v24, 3, v23
  v_add_u32 v229, 162304, v23
  v_and_b32 v26, 3, v1
  v_lshlrev_b32 v24, 5, v24
  v_and_b32 v27, 4, v1
  v_lshl_add_u32 v24, v27, 2, v24
  v_lshl_add_u32 v230, v26, 15, v24
  s_movk_i32 s4, 14336
  v_mul_lo_u32 v231, v26, s4
  v_add_u32 v231, v231, v24
  s_mul_i32 s4, s3, 224
  s_mul_i32 s5, s33, 224
  s_sub_u32 s4, s4, s5
  s_add_u32 s4, s4, 162304
  v_add_u32 v232, s4, v25
  s_mul_i32 s38, s33, 14
  s_lshl_b64 s[92:93], 0x3fff, s38
  s_lshl_b32 s5, s3, 7
  s_lshl_b32 s4, s34, 9
  s_add_u32 s4, s4, s5
  s_lshl_b32 s39, s33, 17
  s_add_u32 s4, s4, s39
  s_add_u32 s4, s4, 65536
  s_lshl_b32 s36, s35, 9
  s_add_u32 s36, s36, s5
  s_mul_i32 s5, s37, 229376
  s_add_u32 s36, s36, s5
  s_mul_i32 s5, s33, 57344
  s_add_u32 s36, s36, s5
  s_add_u32 s36, s36, 589824
  s_mov_b32 s5, 0x00ff00ff
  s_waitcnt lgkmcnt(0)
  s_mul_i32 s65, s64, 0x9E3779B1
  s_add_u32 s65, s65, 0x7F4A7C15
  v_mov_b32 v38, s65
  v_mov_b32 v93, s65
  v_mov_b32 v95, s65
  v_mov_b32 v97, s65
  v_mov_b32 v99, s65
  s_waitcnt vmcnt(4)
  v_lshlrev_b32 v48, 16, v44
  v_and_b32 v49, 0xffff0000, v44
  v_lshlrev_b32 v50, 16, v45
  v_and_b32 v51, 0xffff0000, v45
  v_lshlrev_b32 v52, 16, v46
  v_and_b32 v53, 0xffff0000, v46
  v_lshlrev_b32 v54, 16, v47
  v_and_b32 v55, 0xffff0000, v47
  v_pk_add_f32 v[22:23], v[48:49], v[50:51]
  v_pk_add_f32 v[26:27], v[52:53], v[54:55]
  v_pk_add_f32 v[22:23], v[22:23], v[26:27]
  v_add_f32 v22, v22, v23
  s_nop 1
  v_add_f32_dpp v22, v22, v22 row_ror:8 row_mask:0xf bank_mask:0xf
  s_nop 1
  v_add_f32_dpp v22, v22, v22 row_ror:4 row_mask:0xf bank_mask:0xf
  s_nop 1
  v_add_f32_dpp v22, v22, v22 row_ror:2 row_mask:0xf bank_mask:0xf
  s_nop 1
  v_add_f32_dpp v22, v22, v22 row_ror:1 row_mask:0xf bank_mask:0xf
  v_mov_b32 v24, v22
  s_nop 1
  v_permlane16_swap_b32 v24, v22
  s_nop 0
  v_add_f32 v22, v22, v24
  v_mov_b32 v24, v22
  s_nop 1
  v_permlane32_swap_b32 v24, v22
  s_nop 0
  v_add_f32 v22, v22, v24
  v_mul_f32 v22, 0x3b124925, v22
  v_mov_b32 v26, 0
  v_mov_b32 v27, 0
  v_mov_b32 v23, v22
  s_mov_b32 exec_lo, 0xffffffff
  s_mov_b32 exec_hi, 0xffffff
  v_pk_add_f32 v[30:31], v[48:49], v[22:23] neg_lo:[0,1] neg_hi:[0,1]
  v_pk_fma_f32 v[26:27], v[30:31], v[30:31], v[26:27]
  v_pk_add_f32 v[30:31], v[50:51], v[22:23] neg_lo:[0,1] neg_hi:[0,1]
  v_pk_fma_f32 v[26:27], v[30:31], v[30:31], v[26:27]
  v_pk_add_f32 v[30:31], v[52:53], v[22:23] neg_lo:[0,1] neg_hi:[0,1]
  v_pk_fma_f32 v[26:27], v[30:31], v[30:31], v[26:27]
  v_pk_add_f32 v[30:31], v[54:55], v[22:23] neg_lo:[0,1] neg_hi:[0,1]
  v_pk_fma_f32 v[26:27], v[30:31], v[30:31], v[26:27]
  s_mov_b64 exec, -1
  v_add_f32 v26, v26, v27
  s_nop 1
  v_add_f32_dpp v26, v26, v26 row_ror:8 row_mask:0xf bank_mask:0xf
  s_nop 1
  v_add_f32_dpp v26, v26, v26 row_ror:4 row_mask:0xf bank_mask:0xf
  s_nop 1
  v_add_f32_dpp v26, v26, v26 row_ror:2 row_mask:0xf bank_mask:0xf
  s_nop 1
  v_add_f32_dpp v26, v26, v26 row_ror:1 row_mask:0xf bank_mask:0xf
  v_mov_b32 v24, v26
  s_nop 1
  v_permlane16_swap_b32 v24, v26
  s_nop 0
  v_add_f32 v26, v26, v24
  v_mov_b32 v24, v26
  s_nop 1
  v_permlane32_swap_b32 v24, v26
  s_nop 0
  v_add_f32 v26, v26, v24
  v_mul_f32 v26, 0x3b124925, v26
  v_cvt_pk_bf16_f32 v26, v26, v26
  v_lshlrev_b32 v26, 16, v26
  v_add_f32 v26, 0x3727c5ac, v26
  v_cvt_pk_bf16_f32 v26, v26, v26
  v_lshlrev_b32 v26, 16, v26
  v_sqrt_f32 v26, v26
  v_cvt_pk_bf16_f32 v22, v22, v22
  v_lshlrev_b32 v22, 16, v22
  v_cvt_pk_bf16_f32 v26, v26, v26
  v_lshlrev_b32 v26, 16, v26
  v_mov_b32 v23, v22
  v_rcp_f32 v26, v26
  v_pk_add_f32 v[48:49], v[48:49], v[22:23] neg_lo:[0,1] neg_hi:[0,1]
  v_pk_add_f32 v[50:51], v[50:51], v[22:23] neg_lo:[0,1] neg_hi:[0,1]
  v_pk_add_f32 v[52:53], v[52:53], v[22:23] neg_lo:[0,1] neg_hi:[0,1]
  v_pk_add_f32 v[54:55], v[54:55], v[22:23] neg_lo:[0,1] neg_hi:[0,1]
  v_mov_b32 v27, v26
  v_cvt_pk_bf16_f32 v44, v48, v49
  v_cvt_pk_bf16_f32 v45, v50, v51
  v_cvt_pk_bf16_f32 v46, v52, v53
  v_cvt_pk_bf16_f32 v47, v54, v55
  v_lshlrev_b32 v48, 16, v44
  v_and_b32 v49, 0xffff0000, v44
  v_lshlrev_b32 v50, 16, v45
  v_and_b32 v51, 0xffff0000, v45
  v_lshlrev_b32 v52, 16, v46
  v_and_b32 v53, 0xffff0000, v46
  v_lshlrev_b32 v54, 16, v47
  v_and_b32 v55, 0xffff0000, v47
  v_pk_mul_f32 v[48:49], v[48:49], v[26:27]
  v_pk_mul_f32 v[50:51], v[50:51], v[26:27]
  v_pk_mul_f32 v[52:53], v[52:53], v[26:27]
  v_pk_mul_f32 v[54:55], v[54:55], v[26:27]
  v_cvt_pk_bf16_f32 v44, v48, v49
  v_cvt_pk_bf16_f32 v45, v50, v51
  v_cvt_pk_bf16_f32 v46, v52, v53
  v_cvt_pk_bf16_f32 v47, v54, v55
  s_mov_b64 exec, s[92:93]
  ds_write_b128 v232, v[44:47]
  s_mov_b64 exec, -1
  s_waitcnt vmcnt(0) lgkmcnt(0)
  s_mov_b64 exec, 1
  ds_add_u32 v236, v237 offset:0
  s_mov_b64 exec, -1
  s_mov_b32 s71, 0x400000
L_ldswait_16:
  ds_read_b32 v30, v236 offset:0
  s_waitcnt lgkmcnt(0)
  v_readfirstlane_b32 s32, v30
  s_cmp_ge_u32 s32, 4
  s_cbranch_scc1 L_ldsdone_17
  s_sub_u32 s71, s71, 1
  s_cmp_lg_u32 s71, 0
  s_cbranch_scc1 L_ldswait_16
L_ldsdone_17:
  ds_read_b64 v[76:77], v229 offset:0
  ds_read_b64_tr_b16 v[108:109], v228 offset:0
  ds_read_b64 v[78:79], v229 offset:32
  ds_read_b64_tr_b16 v[110:111], v228 offset:2048
  ds_read_b64 v[80:81], v229 offset:64
  ds_read_b64_tr_b16 v[112:113], v228 offset:4096
  ds_read_b64 v[82:83], v229 offset:96
  ds_read_b64_tr_b16 v[114:115], v228 offset:6144
  ds_read_b64 v[84:85], v229 offset:128
  ds_read_b64_tr_b16 v[116:117], v228 offset:8192
  ds_read_b64 v[86:87], v229 offset:160
  ds_read_b64_tr_b16 v[118:119], v228 offset:10240
  ds_read_b64 v[88:89], v229 offset:192
  ds_read_b64_tr_b16 v[120:121], v228 offset:12288
  s_waitcnt lgkmcnt(12)
  v_mfma_f32_16x16x16_bf16 v[40:43], v[108:109], v[76:77], 0
  s_waitcnt lgkmcnt(10)
  v_mfma_f32_16x16x16_bf16 v[40:43], v[110:111], v[78:79], v[40:43]
  s_waitcnt lgkmcnt(8)
  v_mfma_f32_16x16x16_bf16 v[40:43], v[112:113], v[80:81], v[40:43]
  s_waitcnt lgkmcnt(6)
  v_mfma_f32_16x16x16_bf16 v[40:43], v[114:115], v[82:83], v[40:43]
  s_waitcnt lgkmcnt(4)
  v_mfma_f32_16x16x16_bf16 v[40:43], v[116:117], v[84:85], v[40:43]
  s_waitcnt lgkmcnt(2)
  v_mfma_f32_16x16x16_bf16 v[40:43], v[118:119], v[86:87], v[40:43]
  s_waitcnt lgkmcnt(0)
  v_mfma_f32_16x16x16_bf16 v[40:43], v[120:121], v[88:89], v[40:43]
  s_mov_b32 exec_lo, s5
  s_mov_b32 exec_hi, s5
  v_and_b32 v96, 4, v1
  v_cmp_ne_u32 vcc, 0, v96
  s_nop 4
  v_cndmask_b32 v92, v40, v42, vcc
  v_cndmask_b32 v94, v41, v43, vcc
  buffer_store_dwordx4 v[92:95], v230, s[16:19], s4 offen sc1
  s_mov_b64 exec, -1
  s_add_u32 m0, s7, 145408
  s_nop 0
  buffer_load_dwordx4 v234, s[24:27], s6 offen nt lds
  s_add_u32 s6, s6, 28672
  s_add_u32 m0, s7, 146432
  s_nop 0
  buffer_load_dwordx4 v234, s[24:27], s6 offen nt lds
  s_add_u32 s6, s6, 28672
  s_add_u32 m0, s7, 147456
  s_nop 0
  buffer_load_dwordx4 v234, s[24:27], s6 offen nt lds
  s_add_u32 s6, s6, 28672
  s_add_u32 m0, s7, 148480
  s_mov_b32 exec_lo, 0xffffffff
  s_mov_b32 exec_hi, 0x0
  buffer_load_dwordx4 v234, s[24:27], s6 offen nt lds
  s_mov_b64 exec, -1
  s_waitcnt vmcnt(0)
  s_mov_b64 exec, 1
  ds_add_u32 v236, v237 offset:8
  s_mov_b64 exec, -1
  s_mov_b32 s71, 0x400000
L_ldswait_18:
  ds_read_b32 v30, v236 offset:8
  s_waitcnt lgkmcnt(0)
  v_readfirstlane_b32 s32, v30
  s_cmp_ge_u32 s32, 4
  s_cbranch_scc1 L_ldsdone_19
  s_sub_u32 s71, s71, 1
  s_cmp_lg_u32 s71, 0
  s_cbranch_scc1 L_ldswait_18
L_ldsdone_19:
  ds_read_b64_tr_b16 v[128:129], v228 offset:14336
  ds_read_b64_tr_b16 v[130:131], v228 offset:16384
  ds_read_b64_tr_b16 v[132:133], v228 offset:18432
  ds_read_b64_tr_b16 v[134:135], v228 offset:20480
  ds_read_b64_tr_b16 v[136:137], v228 offset:22528
  ds_read_b64_tr_b16 v[138:139], v228 offset:24576
  ds_read_b64_tr_b16 v[140:141], v228 offset:26624
  s_waitcnt lgkmcnt(6)
  v_mfma_f32_16x16x16_bf16 v[124:127], v[128:129], v[76:77], 0
  s_waitcnt lgkmcnt(5)
  v_mfma_f32_16x16x16_bf16 v[124:127], v[130:131], v[78:79], v[124:127]
  s_waitcnt lgkmcnt(4)
  v_mfma_f32_16x16x16_bf16 v[124:127], v[132:133], v[80:81], v[124:127]
  s_waitcnt lgkmcnt(3)
  v_mfma_f32_16x16x16_bf16 v[124:127], v[134:135], v[82:83], v[124:127]
  s_waitcnt lgkmcnt(2)
  v_mfma_f32_16x16x16_bf16 v[124:127], v[136:137], v[84:85], v[124:127]
  s_waitcnt lgkmcnt(1)
  v_mfma_f32_16x16x16_bf16 v[124:127], v[138:139], v[86:87], v[124:127]
  s_waitcnt lgkmcnt(0)
  v_mfma_f32_16x16x16_bf16 v[124:127], v[140:141], v[88:89], v[124:127]
  s_cmp_ge_u32 s2, 224
  s_cbranch_scc1 L_noffn_20
  s_mov_b32 exec_lo, s5
  s_mov_b32 exec_hi, s5
  v_and_b32 v96, 4, v1
  v_cmp_ne_u32 vcc, 0, v96
  s_nop 4
  v_cndmask_b32 v92, v124, v126, vcc
  v_cndmask_b32 v94, v125, v127, vcc
  buffer_store_dwordx4 v[92:95], v231, s[16:19], s36 offen sc1
  s_mov_b64 exec, -1
L_noffn_20:
  s_lshr_b32 s4, s2, 6
  s_bfe_u32 s5, s2, 0x30003
  s_lshl_b32 s6, s4, 15
  s_lshl_b32 s7, s5, 12
  s_add_u32 s6, s6, s7
  s_lshl_b32 s7, s3, 10
  s_add_u32 s6, s6, s7
  s_add_u32 s6, s6, 65536
  v_lshlrev_b32 v22, 4, v1
  v_lshlrev_b32 v24, 2, v1
  s_lshl_b32 s4, s3, 8
  s_add_u32 s4, s4, 159744
  v_add_u32 v24, s4, v24
  s_mov_b32 s71, 0x40000
L_pollq_21:
  s_add_u32 s38, s6, 0
  buffer_load_dwordx4 v[44:47], v22, s[16:19], s38 offen sc1
  s_add_u32 s38, s6, 131072
  buffer_load_dwordx4 v[48:51], v22, s[16:19], s38 offen sc1
  s_add_u32 s38, s6, 262144
  buffer_load_dwordx4 v[52:55], v22, s[16:19], s38 offen sc1
  s_add_u32 s38, s6, 393216
  buffer_load_dwordx4 v[56:59], v22, s[16:19], s38 offen sc1
  s_waitcnt vmcnt(0)
L_pollq_chk_23:
  v_xor_b32 v23, v45, v38
  v_xor_b32 v30, v49, v38
  v_xor_b32 v31, v53, v38
  v_or3_b32 v23, v23, v30, v31
  v_xor_b32 v30, v57, v38
  v_xor_b32 v31, v47, v38
  v_or3_b32 v23, v23, v30, v31
  v_xor_b32 v30, v51, v38
  v_xor_b32 v31, v55, v38
  v_or3_b32 v23, v23, v30, v31
  v_xor_b32 v30, v59, v38
  v_or_b32 v23, v23, v30
  v_cmp_ne_u32 vcc, 0, v23
  s_cbranch_vccz L_pollq_done_22
  s_sub_u32 s71, s71, 1
  s_cmp_lg_u32 s71, 0
  s_cbranch_scc1 L_pollq_21
L_pollq_done_22:
  v_add_f32 v44, v44, v48
  v_add_f32 v52, v52, v56
  v_add_f32 v46, v46, v50
  v_add_f32 v54, v54, v58
  v_add_f32 v44, v44, v52
  v_add_f32 v46, v46, v54
  v_cvt_pk_bf16_f32 v44, v44, v46
  ds_write_b32 v24, v44
  s_waitcnt lgkmcnt(0)
  s_mov_b64 exec, 1
  ds_add_u32 v236, v237 offset:4
  s_mov_b64 exec, -1
  s_mov_b32 s20, s48
  s_and_b32 s21, s49, 0xffff
  s_mov_b32 s22, 3670016
  s_mov_b32 s23, 0x20000
  s_mov_b32 s24, s56
  s_and_b32 s25, s57, 0xffff
  s_mov_b32 s26, 1605632
  s_mov_b32 s27, 0x20000
  v_lshrrev_b32 v25, 3, v1
  s_movk_i32 s4, 896
  v_mul_lo_u32 v25, v25, s4
  v_and_b32 v26, 7, v1
  v_lshl_add_u32 v25, v26, 4, v25
  s_and_b32 s4, s2, 7
  s_lshr_b32 s5, s2, 6
  s_bfe_u32 s6, s2, 0x30003
  s_min_u32 s6, s6, 6
  s_lshl_b32 s7, s4, 9
  s_lshl_b32 s38, s5, 7
  s_add_u32 s7, s7, s38
  s_lshl_b32 s38, s3, 5
  s_add_u32 s7, s7, s38
  s_mul_i32 s7, s7, 896
  s_lshl_b32 s6, s6, 7
  s_add_u32 s7, s7, s6
  s_lshl_b32 s38, s3, 12
  s_mov_b32 s71, 0x400000
L_ldswait_24:
  ds_read_b32 v30, v236 offset:4
  s_waitcnt lgkmcnt(0)
  v_readfirstlane_b32 s32, v30
  s_cmp_ge_u32 s32, 4
  s_cbranch_scc1 L_ldsdone_25
  s_sleep 1
  s_sub_u32 s71, s71, 1
  s_cmp_lg_u32 s71, 0
  s_cbranch_scc1 L_ldswait_24
L_ldsdone_25:
  s_add_u32 m0, s38, 131072
  s_nop 0
  buffer_load_dwordx4 v25, s[20:23], s7 offen nt lds
  s_add_u32 s7, s7, 7168
  s_add_u32 m0, s38, 132096
  s_nop 0
  buffer_load_dwordx4 v25, s[20:23], s7 offen nt lds
  s_add_u32 s7, s7, 7168
  s_add_u32 m0, s38, 133120
  s_nop 0
  buffer_load_dwordx4 v25, s[20:23], s7 offen nt lds
  s_add_u32 s7, s7, 7168
  s_add_u32 m0, s38, 134144
  s_nop 0
  buffer_load_dwordx4 v25, s[20:23], s7 offen nt lds
  s_lshl_b32 s4, s4, 2
  s_add_u32 s4, s4, s5
  s_mul_i32 s33, s4, 448
  s_mul_i32 s4, s4, 56
  s_lshl_b32 s5, s3, 4
  s_add_u32 s4, s4, s5
  s_mul_i32 s4, s4, 896
  s_add_u32 s4, s4, s6
  s_lshl_b32 s38, s3, 11
  s_add_u32 m0, s38, 147456
  s_nop 0
  buffer_load_dwordx4 v25, s[24:27], s4 offen nt lds
  s_add_u32 s4, s4, 7168
  s_add_u32 m0, s38, 148480
  s_nop 0
  buffer_load_dwordx4 v25, s[24:27], s4 offen nt lds
  s_mul_i32 s38, s3, 14336
  s_add_u32 s33, s33, s38
  s_add_u32 s33, s33, 589824
  v_lshlrev_b32 v22, 4, v1
  v_mov_b32 v205, v38
  v_mov_b32 v207, v38
  v_mov_b32 v204, 0
  v_mov_b32 v206, 0
  v_mov_b32 v209, v38
  v_mov_b32 v211, v38
  v_mov_b32 v208, 0
  v_mov_b32 v210, 0
  v_mov_b32 v213, v38
  v_mov_b32 v215, v38
  v_mov_b32 v212, 0
  v_mov_b32 v214, 0
  v_mov_b32 v217, v38
  v_mov_b32 v219, v38
  v_mov_b32 v216, 0
  v_mov_b32 v218, 0
  v_mov_b32 v221, v38
  v_mov_b32 v223, v38
  v_mov_b32 v220, 0
  v_mov_b32 v222, 0
  v_mov_b32 v225, v38
  v_mov_b32 v227, v38
  v_mov_b32 v224, 0
  v_mov_b32 v226, 0
  v_mov_b32 v229, v38
  v_mov_b32 v231, v38
  v_mov_b32 v228, 0
  v_mov_b32 v230, 0
  v_mov_b32 v233, v38
  v_mov_b32 v235, v38
  v_mov_b32 v232, 0
  v_mov_b32 v234, 0
  s_mov_b32 s71, 0x40000
L_pollgu_26:
  s_mov_b32 exec_lo, 0xfffffff
  s_mov_b32 exec_hi, 0x0
  s_add_u32 s38, s33, 0
  buffer_load_dwordx4 v[204:207], v22, s[16:19], s38 offen sc1
  s_add_u32 s38, s33, 57344
  buffer_load_dwordx4 v[208:211], v22, s[16:19], s38 offen sc1
  s_add_u32 s38, s33, 114688
  buffer_load_dwordx4 v[212:215], v22, s[16:19], s38 offen sc1
  s_add_u32 s38, s33, 172032
  buffer_load_dwordx4 v[216:219], v22, s[16:19], s38 offen sc1
  s_add_u32 s38, s33, 229376
  buffer_load_dwordx4 v[220:223], v22, s[16:19], s38 offen sc1
  s_add_u32 s38, s33, 286720
  buffer_load_dwordx4 v[224:227], v22, s[16:19], s38 offen sc1
  s_add_u32 s38, s33, 344064
  buffer_load_dwordx4 v[228:231], v22, s[16:19], s38 offen sc1
  s_add_u32 s38, s33, 401408
  buffer_load_dwordx4 v[232:235], v22, s[16:19], s38 offen sc1
  s_mov_b64 exec, -1
  s_waitcnt vmcnt(0)
L_pollgu_chk_28:
  v_xor_b32 v23, v205, v38
  v_xor_b32 v30, v209, v38
  v_xor_b32 v31, v213, v38
  v_or3_b32 v23, v23, v30, v31
  v_xor_b32 v30, v217, v38
  v_xor_b32 v31, v221, v38
  v_or3_b32 v23, v23, v30, v31
  v_xor_b32 v30, v225, v38
  v_xor_b32 v31, v229, v38
  v_or3_b32 v23, v23, v30, v31
  v_xor_b32 v30, v233, v38
  v_xor_b32 v31, v207, v38
  v_or3_b32 v23, v23, v30, v31
  v_xor_b32 v30, v211, v38
  v_xor_b32 v31, v215, v38
  v_or3_b32 v23, v23, v30, v31
  v_xor_b32 v30, v219, v38
  v_xor_b32 v31, v223, v38
  v_or3_b32 v23, v23, v30, v31
  v_xor_b32 v30, v227, v38
  v_xor_b32 v31, v231, v38
  v_or3_b32 v23, v23, v30, v31
  v_xor_b32 v30, v235, v38
  v_or_b32 v23, v23, v30
  v_cmp_ne_u32 vcc, 0, v23
  s_cbranch_vccz L_pollgu_done_27
  s_sub_u32 s71, s71, 1
  s_cmp_lg_u32 s71, 0
  s_cbranch_scc1 L_pollgu_26
L_pollgu_done_27:
  v_add_f32 v204, v204, v208
  v_add_f32 v212, v212, v216
  v_add_f32 v204, v204, v212
  v_cvt_pk_bf16_f32 v204, v204, v204
  v_lshlrev_b32 v204, 16, v204
  v_add_f32 v206, v206, v210
  v_add_f32 v214, v214, v218
  v_add_f32 v206, v206, v214
  v_cvt_pk_bf16_f32 v206, v206, v206
  v_lshlrev_b32 v206, 16, v206
  v_add_f32 v220, v220, v224
  v_add_f32 v228, v228, v232
  v_add_f32 v220, v220, v228
  v_cvt_pk_bf16_f32 v220, v220, v220
  v_lshlrev_b32 v220, 16, v220
  v_add_f32 v222, v222, v226
  v_add_f32 v230, v230, v234
  v_add_f32 v222, v222, v230
  v_cvt_pk_bf16_f32 v222, v222, v222
  v_lshlrev_b32 v222, 16, v222
  v_mul_f32 v26, v204, v204
  v_mul_f32 v26, v26, v204
  v_mov_b32 v27, 0x3d372713
  v_fma_f32 v26, v26, v27, v204
  v_mul_f32 v26, 0x40135761, v26
  v_exp_f32 v26, v26
  s_nop 0
  v_add_f32 v26, 1.0, v26
  v_rcp_f32 v26, v26
  s_nop 0
  v_fma_f32 v26, v26, -2.0, 1.0
  v_add_f32 v26, 1.0, v26
  v_mul_f32 v27, 0.5, v204
  v_mul_f32 v204, v27, v26
  v_cvt_pk_bf16_f32 v204, v204, v204
  v_lshlrev_b32 v204, 16, v204
  v_mul_f32 v26, v206, v206
  v_mul_f32 v26, v26, v206
  v_mov_b32 v27, 0x3d372713
  v_fma_f32 v26, v26, v27, v206
  v_mul_f32 v26, 0x40135761, v26
  v_exp_f32 v26, v26
  s_nop 0
  v_add_f32 v26, 1.0, v26
  v_rcp_f32 v26, v26
  s_nop 0
  v_fma_f32 v26, v26, -2.0, 1.0
  v_add_f32 v26, 1.0, v26
  v_mul_f32 v27, 0.5, v206
  v_mul_f32 v206, v27, v26
  v_cvt_pk_bf16_f32 v206, v206, v206
  v_lshlrev_b32 v206, 16, v206
  v_mul_f32 v204, v204, v220
  v_mul_f32 v206, v206, v222
  v_cvt_pk_bf16_f32 v204, v204, v206
  s_mul_i32 s4, s3, 384
  s_add_u32 s4, s4, 161024
  v_lshlrev_b32 v23, 2, v1
  v_add_u32 v24, s4, v23
  s_mov_b32 exec_lo, 0xffffffff
  s_mov_b32 exec_hi, 0x0
  ds_write_b32 v24, v204
  s_mov_b64 exec, -1
  v_subrev_u32 v149, 256, v0
  v_lshrrev_b32 v140, 7, v149
  v_and_b32 v141, 127, v149
  v_lshlrev_b32 v142, 10, v140
  v_lshl_add_u32 v142, v141, 3, v142
  v_lshlrev_b32 v143, 3, v140
  v_add_u32 v144, 65536, v142
  v_add_u32 v145, 65536, v143
  v_lshlrev_b32 v146, 3, v149
  v_lshlrev_b32 v147, 4, v140
  s_lshl_b32 s98, s2, 11
  s_add_u32 s98, s98, 1048576
  s_lshl_b32 s99, s2, 5
  s_add_u32 s99, s99, 2097152
  v_mov_b32 v65, v38
  v_mov_b32 v67, v38
  v_mov_b32 v69, v38
  v_mov_b32 v71, v38
  v_mov_b32 v152, 0
  v_mov_b32 v153, 0
  v_mov_b32 v154, 0
  v_mov_b32 v155, 0
  v_mov_b32 v156, 0
  v_mov_b32 v157, 0
  v_mov_b32 v158, 0
  v_mov_b32 v159, 0
  s_bfe_u32 s6, s2, 0x30003
  s_and_b32 s4, s2, 7
  s_lshr_b32 s5, s2, 6
  s_cmp_eq_u32 s6, 7
  s_cbranch_scc1 parallel_sum__gqa_block_cached__glu_gated_geglu__decode_kernel_pre3
  s_lshl_b32 s7, s3, 3
  s_add_u32 s7, s7, s4
  s_lshl_b32 s38, s7, 14
  s_lshl_b32 s39, s5, 9
  s_add_u32 s38, s38, s39
  s_add_u32 s38, s38, 1048576
  s_lshl_b32 s39, s7, 8
  s_lshr_b32 s33, s5, 1
  s_lshl_b32 s33, s33, 4
  s_add_u32 s39, s39, s33
  s_add_u32 s39, s39, 2097152
  v_and_b32 v152, 31, v1
  v_lshlrev_b32 v152, 4, v152
  v_lshrrev_b32 v153, 5, v1
  v_lshl_add_u32 v152, v153, 13, v152
  v_and_b32 v153, 7, v1
  v_lshlrev_b32 v153, 5, v153
  v_lshrrev_b32 v154, 2, v1
  v_lshlrev_b32 v154, 7, v154
  v_and_b32 v155, 3, v1
  v_lshl_add_u32 v154, v155, 3, v154
  s_lshl_b32 s7, s3, 5
  s_add_u32 s7, s7, 131072
  v_add_u32 v154, s7, v154
  v_mul_u32_u24 v155, 384, v155
  v_lshrrev_b32 v156, 4, v1
  v_lshl_add_u32 v155, v156, 3, v155
  v_add_u32 v155, 160768, v155
  v_and_b32 v157, 3, v1
  s_movk_i32 s7, 3584
  v_mul_lo_u32 v157, v157, s7
  v_lshl_add_u32 v157, v156, 5, v157
  v_and_b32 v159, 4, v1
  v_lshl_add_u32 v157, v159, 2, v157
  s_lshl_b32 s36, s4, 2
  s_add_u32 s36, s36, s5
  s_mul_i32 s36, s36, 14336
  s_lshl_b32 s7, s6, 9
  s_add_u32 s36, s36, s7
  s_lshl_b32 s7, s3, 7
  s_add_u32 s36, s36, s7
  s_add_u32 s36, s36, 2105344
  s_mul_i32 s7, s3, 384
  s_add_u32 s7, s7, 160768
  v_and_b32 v158, 31, v1
  v_lshlrev_b32 v158, 3, v158
  v_add_u32 v158, s7, v158
  s_mov_b32 s5, 0x00ff00ff
  s_branch parallel_sum__gqa_block_cached__glu_gated_geglu__decode_kernel_predone
parallel_sum__gqa_block_cached__glu_gated_geglu__decode_kernel_pre3:
  v_lshrrev_b32 v152, 3, v1
  s_mov_b32 s7, 14336
  v_mul_lo_u32 v152, v152, s7
  v_and_b32 v153, 7, v1
  v_lshl_add_u32 v152, v153, 4, v152
  s_mul_i32 s37, s5, 3584
  s_lshl_b32 s7, s4, 9
  s_add_u32 s37, s37, s7
  s_lshl_b32 s7, s3, 7
  s_add_u32 s37, s37, s7
  s_add_u32 s37, s37, 2105344
  s_mul_i32 s38, s5, 896
  s_lshl_b32 s7, s4, 7
  s_add_u32 s38, s38, s7
  s_lshl_b32 s7, s3, 5
  s_add_u32 s38, s38, s7
  v_lshlrev_b32 v154, 2, v153
  s_mov_b32 s28, s40
  s_and_b32 s29, s41, 0xffff
  s_mov_b32 s30, 3584
  s_mov_b32 s31, 0x20000
  s_mov_b32 s20, s58
  s_and_b32 s21, s59, 0xffff
  s_mov_b32 s22, 3584
  s_mov_b32 s23, 0x20000
  buffer_load_dword v155, v154, s[28:31], s38 offen nt
parallel_sum__gqa_block_cached__glu_gated_geglu__decode_kernel_predone:
  s_waitcnt vmcnt(0) lgkmcnt(0)
  s_mov_b64 exec, 1
  ds_add_u32 v236, v237 offset:20
  s_mov_b64 exec, -1
  s_mov_b32 s71, 0x400000
L_ldswait_29:
  ds_read_b32 v30, v236 offset:20
  s_waitcnt lgkmcnt(0)
  v_readfirstlane_b32 s32, v30
  s_cmp_ge_u32 s32, 4
  s_cbranch_scc1 L_ldsdone_30
  s_sleep 2
  s_sub_u32 s71, s71, 1
  s_cmp_lg_u32 s71, 0
  s_cbranch_scc1 L_ldswait_29
L_ldsdone_30:
  s_cmp_eq_u32 s6, 7
  s_cbranch_scc1 L_nopre2_31
  ds_read_b64_tr_b16 v[80:81], v154 offset:0
  ds_read_b64_tr_b16 v[82:83], v154 offset:2048
  ds_read_b64_tr_b16 v[84:85], v154 offset:4096
  ds_read_b64_tr_b16 v[86:87], v154 offset:6144
  ds_read_b64_tr_b16 v[88:89], v154 offset:8192
  ds_read_b64_tr_b16 v[90:91], v154 offset:10240
  ds_read_b64_tr_b16 v[92:93], v154 offset:12288
  ds_read_b64_tr_b16 v[94:95], v154 offset:14336
  ds_read_b64_tr_b16 v[96:97], v154 offset:16384
  ds_read_b64_tr_b16 v[98:99], v154 offset:18432
  ds_read_b64_tr_b16 v[100:101], v154 offset:20480
  ds_read_b64_tr_b16 v[102:103], v154 offset:22528
  s_add_u32 s33, s38, 4096
  s_waitcnt lgkmcnt(0)
L_nopre2_31:
  s_mov_b32 s71, 0x400000
L_ldswait_32:
  ds_read_b32 v30, v236 offset:16
  s_waitcnt lgkmcnt(0)
  v_readfirstlane_b32 s32, v30
  s_cmp_ge_u32 s32, 4
  s_cbranch_scc1 L_ldsdone_33
  s_sleep 4
  s_sub_u32 s71, s71, 1
  s_cmp_lg_u32 s71, 0
  s_cbranch_scc1 L_ldswait_32
L_ldsdone_33:
  ds_read_b64 v[52:53], v143 offset:2048
  ds_read_b64 v[54:55], v143 offset:34816
  ds_read_b64 v[56:57], v145 offset:2048
  ds_read_b64 v[58:59], v145 offset:34816
  s_waitcnt lgkmcnt(0)
  v_max3_f32 v60, v52, v54, v56
  v_max_f32 v60, v60, v58
  v_sub_f32 v52, v52, v60
  v_sub_f32 v54, v54, v60
  v_sub_f32 v56, v56, v60
  v_sub_f32 v58, v58, v60
  v_exp_f32 v52, v52
  v_exp_f32 v54, v54
  v_exp_f32 v56, v56
  v_exp_f32 v58, v58
  v_mov_b32 v68, v60
  v_mul_f32 v70, v53, v52
  v_fmac_f32 v70, v55, v54
  v_fmac_f32 v70, v57, v56
  v_fmac_f32 v70, v59, v58
  v_cmp_eq_u32 vcc, 0, v141
  s_and_saveexec_b64 s[92:93], vcc
  s_cbranch_execz parallel_sum__gqa_block_cached__glu_gated_geglu__decode_kernel_noml
  buffer_store_dwordx4 v[68:71], v147, s[16:19], s99 offen sc1
parallel_sum__gqa_block_cached__glu_gated_geglu__decode_kernel_noml:
  s_mov_b64 exec, -1
  s_barrier
  ds_read_b64 v[44:45], v142 offset:0
  ds_read_b64 v[46:47], v142 offset:32768
  ds_read_b64 v[48:49], v144 offset:0
  ds_read_b64 v[50:51], v144 offset:32768
  s_waitcnt lgkmcnt(3)
  v_mul_f32 v64, v44, v52
  v_mul_f32 v66, v45, v52
  s_waitcnt lgkmcnt(2)
  v_fmac_f32 v64, v46, v54
  v_fmac_f32 v66, v47, v54
  s_waitcnt lgkmcnt(1)
  v_fmac_f32 v64, v48, v56
  v_fmac_f32 v66, v49, v56
  s_waitcnt lgkmcnt(0)
  v_fmac_f32 v64, v50, v58
  v_fmac_f32 v66, v51, v58
  v_cvt_pk_bf16_f32 v64, v64, v66
  s_cmp_eq_u32 s6, 7
  s_cbranch_scc0 parallel_sum__gqa_block_cached__glu_gated_geglu__decode_kernel_st2
  buffer_store_dwordx2 v[64:65], v146, s[16:19], s98 offen sc1
  s_branch parallel_sum__gqa_block_cached__glu_gated_geglu__decode_kernel_stage3
parallel_sum__gqa_block_cached__glu_gated_geglu__decode_kernel_st2:
  buffer_store_dwordx2 v[64:65], v146, s[16:19], s98 offen sc1
  buffer_load_dwordx4 v[76:79], v153, s[16:19], s39 offen sc1
  buffer_load_dwordx4 v[44:47], v152, s[16:19], s38 offen offset:0 sc1
  buffer_load_dwordx4 v[48:51], v152, s[16:19], s38 offen offset:2048 sc1
  buffer_load_dwordx4 v[52:55], v152, s[16:19], s33 offen offset:0 sc1
  buffer_load_dwordx4 v[56:59], v152, s[16:19], s33 offen offset:2048 sc1
  s_waitcnt vmcnt(0)
  v_xor_b32 v23, v45, v38
  v_xor_b32 v30, v49, v38
  v_xor_b32 v31, v53, v38
  v_or3_b32 v23, v23, v30, v31
  v_xor_b32 v30, v57, v38
  v_xor_b32 v31, v47, v38
  v_or3_b32 v23, v23, v30, v31
  v_xor_b32 v30, v51, v38
  v_xor_b32 v31, v55, v38
  v_or3_b32 v23, v23, v30, v31
  v_xor_b32 v30, v59, v38
  v_or_b32 v23, v23, v30
  v_cmp_ne_u32 vcc, 0, v23
  s_cmp_eq_u64 vcc, 0
  s_cselect_b32 s35, 1, 0
  v_xor_b32 v23, v77, v38
  v_xor_b32 v30, v79, v38
  v_or_b32 v23, v23, v30
  v_cmp_ne_u32 vcc, 0, v23
  s_cbranch_vccz L_havew_34
  s_mov_b32 s71, 0x40000
L_poll2a_35:
  s_sleep 2
  buffer_load_dwordx4 v[76:79], v153, s[16:19], s39 offen sc1
  s_waitcnt vmcnt(0)
L_poll2a_chk_37:
  v_xor_b32 v23, v77, v38
  v_xor_b32 v30, v79, v38
  v_or_b32 v23, v23, v30
  v_cmp_ne_u32 vcc, 0, v23
  s_cbranch_vccz L_poll2a_done_36
  s_sub_u32 s71, s71, 1
  s_cmp_lg_u32 s71, 0
  s_cbranch_scc1 L_poll2a_35
L_poll2a_done_36:
L_havew_34:
  v_mov_b32 v25, v76
  s_nop 1
  v_max_f32_dpp v25, v25, v25 row_ror:1 row_mask:0xf bank_mask:0xf
  s_nop 1
  v_max_f32_dpp v25, v25, v25 row_ror:2 row_mask:0xf bank_mask:0xf
  s_nop 1
  v_max_f32_dpp v25, v25, v25 row_ror:4 row_mask:0xf bank_mask:0xf
  v_sub_f32 v26, v76, v25
  v_exp_f32 v26, v26
  s_nop 0
  v_mul_f32 v29, v26, v78
  s_nop 1
  v_add_f32_dpp v29, v29, v29 row_ror:1 row_mask:0xf bank_mask:0xf
  s_nop 1
  v_add_f32_dpp v29, v29, v29 row_ror:2 row_mask:0xf bank_mask:0xf
  s_nop 1
  v_add_f32_dpp v29, v29, v29 row_ror:4 row_mask:0xf bank_mask:0xf
  v_rcp_f32 v29, v29
  s_nop 0
  v_mul_f32 v26, v26, v29
  s_nop 0
  v_readlane_b32 s40, v26, 0
  v_readlane_b32 s41, v26, 1
  v_readlane_b32 s42, v26, 2
  v_readlane_b32 s43, v26, 3
  v_readlane_b32 s44, v26, 4
  v_readlane_b32 s45, v26, 5
  v_readlane_b32 s46, v26, 6
  v_readlane_b32 s47, v26, 7
  s_nop 1
  v_mov_b32 v160, s40
  v_mov_b32 v161, s41
  v_mov_b32 v162, s42
  v_mov_b32 v163, s43
  s_mov_b32 exec_lo, 0
  v_mov_b32 v160, s44
  v_mov_b32 v161, s45
  v_mov_b32 v162, s46
  v_mov_b32 v163, s47
  s_mov_b32 exec_lo, -1
  s_cmp_eq_u32 s35, 1
  s_cbranch_scc1 L_haveo_38
  s_mov_b32 s71, 0x40000
L_poll2b_39:
  buffer_load_dwordx4 v[44:47], v152, s[16:19], s38 offen offset:0 sc1
  buffer_load_dwordx4 v[48:51], v152, s[16:19], s38 offen offset:2048 sc1
  buffer_load_dwordx4 v[52:55], v152, s[16:19], s33 offen offset:0 sc1
  buffer_load_dwordx4 v[56:59], v152, s[16:19], s33 offen offset:2048 sc1
  s_waitcnt vmcnt(0)
L_poll2b_chk_41:
  v_xor_b32 v23, v45, v38
  v_xor_b32 v30, v49, v38
  v_xor_b32 v31, v53, v38
  v_or3_b32 v23, v23, v30, v31
  v_xor_b32 v30, v57, v38
  v_xor_b32 v31, v47, v38
  v_or3_b32 v23, v23, v30, v31
  v_xor_b32 v30, v51, v38
  v_xor_b32 v31, v55, v38
  v_or3_b32 v23, v23, v30, v31
  v_xor_b32 v30, v59, v38
  v_or_b32 v23, v23, v30
  v_cmp_ne_u32 vcc, 0, v23
  s_cbranch_vccz L_poll2b_done_40
  s_sub_u32 s71, s71, 1
  s_cmp_lg_u32 s71, 0
  s_cbranch_scc1 L_poll2b_39
L_poll2b_done_40:
L_haveo_38:
  v_lshlrev_b32 v24, 16, v44
  v_and_b32 v25, 0xffff0000, v44
  v_lshlrev_b32 v26, 16, v46
  v_and_b32 v27, 0xffff0000, v46
  v_mul_f32 v64, v160, v24
  v_mul_f32 v65, v160, v25
  v_mul_f32 v66, v160, v26
  v_mul_f32 v67, v160, v27
  v_lshlrev_b32 v24, 16, v48
  v_and_b32 v25, 0xffff0000, v48
  v_lshlrev_b32 v26, 16, v50
  v_and_b32 v27, 0xffff0000, v50
  v_fmac_f32 v64, v161, v24
  v_fmac_f32 v65, v161, v25
  v_fmac_f32 v66, v161, v26
  v_fmac_f32 v67, v161, v27
  v_lshlrev_b32 v24, 16, v52
  v_and_b32 v25, 0xffff0000, v52
  v_lshlrev_b32 v26, 16, v54
  v_and_b32 v27, 0xffff0000, v54
  v_fmac_f32 v64, v162, v24
  v_fmac_f32 v65, v162, v25
  v_fmac_f32 v66, v162, v26
  v_fmac_f32 v67, v162, v27
  v_lshlrev_b32 v24, 16, v56
  v_and_b32 v25, 0xffff0000, v56
  v_lshlrev_b32 v26, 16, v58
  v_and_b32 v27, 0xffff0000, v58
  v_fmac_f32 v64, v163, v24
  v_fmac_f32 v65, v163, v25
  v_fmac_f32 v66, v163, v26
  v_fmac_f32 v67, v163, v27
  v_mov_b32 v68, v64
  v_mov_b32 v69, v65
  v_mov_b32 v70, v66
  v_mov_b32 v71, v67
  s_nop 0
  v_permlane32_swap_b32 v68, v64
  v_permlane32_swap_b32 v69, v65
  v_permlane32_swap_b32 v70, v66
  v_permlane32_swap_b32 v71, v67
  v_add_f32 v64, v64, v68
  v_add_f32 v65, v65, v69
  v_add_f32 v66, v66, v70
  v_add_f32 v67, v67, v71
  v_cvt_pk_bf16_f32 v64, v64, v65
  v_cvt_pk_bf16_f32 v65, v66, v67
  s_mov_b32 exec_hi, 0
  ds_write_b64 v158, v[64:65]
  s_mov_b32 exec_hi, -1
  s_waitcnt lgkmcnt(0)
  s_barrier
  ds_read_b64 v[104:105], v155 offset:0
  ds_read_b64 v[106:107], v155 offset:32
  ds_read_b64 v[108:109], v155 offset:64
  ds_read_b64 v[110:111], v155 offset:96
  ds_read_b64 v[112:113], v155 offset:128
  ds_read_b64 v[114:115], v155 offset:160
  ds_read_b64 v[116:117], v155 offset:192
  ds_read_b64 v[118:119], v155 offset:224
  ds_read_b64 v[120:121], v155 offset:256
  ds_read_b64 v[122:123], v155 offset:288
  ds_read_b64 v[124:125], v155 offset:320
  ds_read_b64 v[126:127], v155 offset:352
  v_mov_b32 v133, v38
  v_mov_b32 v135, v38
  v_mov_b32 v137, v38
  v_mov_b32 v139, v38
  s_waitcnt lgkmcnt(11)
  v_mfma_f32_16x16x16_bf16 v[40:43], v[80:81], v[104:105], 0
  s_waitcnt lgkmcnt(10)
  v_mfma_f32_16x16x16_bf16 v[128:131], v[82:83], v[106:107], 0
  s_waitcnt lgkmcnt(9)
  v_mfma_f32_16x16x16_bf16 v[40:43], v[84:85], v[108:109], v[40:43]
  s_waitcnt lgkmcnt(8)
  v_mfma_f32_16x16x16_bf16 v[128:131], v[86:87], v[110:111], v[128:131]
  s_waitcnt lgkmcnt(7)
  v_mfma_f32_16x16x16_bf16 v[40:43], v[88:89], v[112:113], v[40:43]
  s_waitcnt lgkmcnt(6)
  v_mfma_f32_16x16x16_bf16 v[128:131], v[90:91], v[114:115], v[128:131]
  s_waitcnt lgkmcnt(5)
  v_mfma_f32_16x16x16_bf16 v[40:43], v[92:93], v[116:117], v[40:43]
  s_waitcnt lgkmcnt(4)
  v_mfma_f32_16x16x16_bf16 v[128:131], v[94:95], v[118:119], v[128:131]
  s_waitcnt lgkmcnt(3)
  v_mfma_f32_16x16x16_bf16 v[40:43], v[96:97], v[120:121], v[40:43]
  s_waitcnt lgkmcnt(2)
  v_mfma_f32_16x16x16_bf16 v[128:131], v[98:99], v[122:123], v[128:131]
  s_waitcnt lgkmcnt(1)
  v_mfma_f32_16x16x16_bf16 v[40:43], v[100:101], v[124:125], v[40:43]
  s_waitcnt lgkmcnt(0)
  v_mfma_f32_16x16x16_bf16 v[128:131], v[102:103], v[126:127], v[128:131]
  s_mov_b32 exec_lo, s5
  s_mov_b32 exec_hi, s5
  v_and_b32 v136, 4, v1
  v_cmp_ne_u32 vcc, 0, v136
  s_nop 3
  v_add_f32 v40, v40, v128
  v_add_f32 v41, v41, v129
  v_add_f32 v42, v42, v130
  v_add_f32 v43, v43, v131
  v_cndmask_b32 v132, v40, v42, vcc
  v_cndmask_b32 v134, v41, v43, vcc
  buffer_store_dwordx4 v[132:135], v157, s[16:19], s36 offen sc1
  s_mov_b64 exec, -1
  s_endpgm
parallel_sum__gqa_block_cached__glu_gated_geglu__decode_kernel_stage3:
  s_cmp_eq_u32 s4, 7
  s_cbranch_scc1 parallel_sum__gqa_block_cached__glu_gated_geglu__decode_kernel_fin
  s_mov_b32 s71, 0x40000
  s_add_u32 s33, s37, 0
  buffer_load_dwordx4 v[44:47], v152, s[16:19], s33 offen sc1
  s_add_u32 s33, s37, 114688
  buffer_load_dwordx4 v[48:51], v152, s[16:19], s33 offen sc1
  s_add_u32 s33, s37, 229376
  buffer_load_dwordx4 v[52:55], v152, s[16:19], s33 offen sc1
  s_add_u32 s33, s37, 344064
  buffer_load_dwordx4 v[56:59], v152, s[16:19], s33 offen sc1
  s_sleep 3
  s_add_u32 s33, s37, 0
  buffer_load_dwordx4 v[60:63], v152, s[16:19], s33 offen sc1
  s_add_u32 s33, s37, 114688
  buffer_load_dwordx4 v[64:67], v152, s[16:19], s33 offen sc1
  s_add_u32 s33, s37, 229376
  buffer_load_dwordx4 v[68:71], v152, s[16:19], s33 offen sc1
  s_add_u32 s33, s37, 344064
  buffer_load_dwordx4 v[72:75], v152, s[16:19], s33 offen sc1
L_poll3_42:
  s_waitcnt vmcnt(4)
  v_xor_b32 v26, v45, v38
  v_xor_b32 v30, v49, v38
  v_xor_b32 v31, v53, v38
  v_or3_b32 v26, v26, v30, v31
  v_xor_b32 v30, v57, v38
  v_xor_b32 v31, v47, v38
  v_or3_b32 v26, v26, v30, v31
  v_xor_b32 v30, v51, v38
  v_xor_b32 v31, v55, v38
  v_or3_b32 v26, v26, v30, v31
  v_xor_b32 v30, v59, v38
  v_or_b32 v26, v26, v30
  v_cmp_ne_u32 vcc, 0, v26
  s_cbranch_vccz L_poll3_a_43
  s_add_u32 s33, s37, 0
  buffer_load_dwordx4 v[44:47], v152, s[16:19], s33 offen sc1
  s_add_u32 s33, s37, 114688
  buffer_load_dwordx4 v[48:51], v152, s[16:19], s33 offen sc1
  s_add_u32 s33, s37, 229376
  buffer_load_dwordx4 v[52:55], v152, s[16:19], s33 offen sc1
  s_add_u32 s33, s37, 344064
  buffer_load_dwordx4 v[56:59], v152, s[16:19], s33 offen sc1
  s_waitcnt vmcnt(4)
  v_xor_b32 v26, v61, v38
  v_xor_b32 v30, v65, v38
  v_xor_b32 v31, v69, v38
  v_or3_b32 v26, v26, v30, v31
  v_xor_b32 v30, v73, v38
  v_xor_b32 v31, v63, v38
  v_or3_b32 v26, v26, v30, v31
  v_xor_b32 v30, v67, v38
  v_xor_b32 v31, v71, v38
  v_or3_b32 v26, v26, v30, v31
  v_xor_b32 v30, v75, v38
  v_or_b32 v26, v26, v30
  v_cmp_ne_u32 vcc, 0, v26
  s_cbranch_vccz L_poll3_b_44
  s_add_u32 s33, s37, 0
  buffer_load_dwordx4 v[60:63], v152, s[16:19], s33 offen sc1
  s_add_u32 s33, s37, 114688
  buffer_load_dwordx4 v[64:67], v152, s[16:19], s33 offen sc1
  s_add_u32 s33, s37, 229376
  buffer_load_dwordx4 v[68:71], v152, s[16:19], s33 offen sc1
  s_add_u32 s33, s37, 344064
  buffer_load_dwordx4 v[72:75], v152, s[16:19], s33 offen sc1
  s_sub_u32 s71, s71, 1
  s_cmp_lg_u32 s71, 0
  s_cbranch_scc1 L_poll3_42
L_poll3_a_43:
  v_add_f32 v80, v44, v48
  v_add_f32 v81, v52, v56
  v_add_f32 v82, v46, v50
  v_add_f32 v83, v54, v58
  v_add_f32 v80, v80, v81
  v_add_f32 v82, v82, v83
  s_branch L_poll3_done_45
L_poll3_b_44:
  v_add_f32 v80, v60, v64
  v_add_f32 v81, v68, v72
  v_add_f32 v82, v62, v66
  v_add_f32 v83, v70, v74
  v_add_f32 v80, v80, v81
  v_add_f32 v82, v82, v83
L_poll3_done_45:
  s_nop 0
  v_add_f32_dpp v80, v80, v80 row_ror:8 row_mask:0xf bank_mask:0xf
  v_add_f32_dpp v82, v82, v82 row_ror:8 row_mask:0xf bank_mask:0xf
  v_mov_b32 v27, v80
  v_mov_b32 v28, v82
  s_nop 0
  v_permlane16_swap_b32 v27, v80
  v_permlane16_swap_b32 v28, v82
  v_add_f32 v80, v80, v27
  v_add_f32 v82, v82, v28
  v_mov_b32 v27, v80
  v_mov_b32 v28, v82
  s_nop 0
  v_permlane32_swap_b32 v27, v80
  v_permlane32_swap_b32 v28, v82
  v_add_f32 v80, v80, v27
  v_add_f32 v82, v82, v28
  v_lshlrev_b32 v26, 16, v155
  v_and_b32 v27, 0xffff0000, v155
  v_add_f32 v80, v80, v26
  v_add_f32 v82, v82, v27
  v_cvt_pk_bf16_f32 v80, v80, v82
  s_mov_b64 exec, 0xff
  buffer_store_dword v80, v154, s[20:23], s38 offen
  s_mov_b64 exec, -1
  s_cmp_eq_u32 s2, 56
  s_cbranch_scc0 parallel_sum__gqa_block_cached__glu_gated_geglu__decode_kernel_fin
  s_cmp_eq_u32 s3, 0
  s_cbranch_scc0 parallel_sum__gqa_block_cached__glu_gated_geglu__decode_kernel_fin
  v_mov_b32 v22, 0
  s_mov_b64 exec, 1
  buffer_store_dword v38, v22, s[16:19], 0 offen sc1
  s_mov_b64 exec, -1
parallel_sum__gqa_block_cached__glu_gated_geglu__decode_kernel_fin:
parallel_sum__gqa_block_cached__glu_gated_geglu__decode_kernel_done:
  s_endpgm

.section .rodata,"a"
.p2align 6
.amdhsa_kernel parallel_sum__gqa_block_cached__glu_gated_geglu__decode_kernel
  .amdhsa_next_free_vgpr 240
  .amdhsa_next_free_sgpr 102
  .amdhsa_accum_offset 240
  .amdhsa_group_segment_fixed_size 0
  .amdhsa_kernarg_size 96
  .amdhsa_user_sgpr_count 2
  .amdhsa_user_sgpr_kernarg_segment_ptr 1
  .amdhsa_system_sgpr_workgroup_id_x 1
  .amdhsa_float_denorm_mode_32 3
  .amdhsa_float_denorm_mode_16_64 3
.end_amdhsa_kernel
```
